```python
import torch

def _softmax(x, axis=-1):
    return torch.softmax(x, dim=axis)
def _gelu(x):
    return torch.nn.functional.gelu(x, approximate="tanh")
def _silu(x):
    return torch.nn.functional.silu(x)
def _sigmoid(x):
    return torch.sigmoid(x)
def _layernorm(x, axis=-1, eps=1e-5):
    m = x.mean(dim=axis, keepdim=True)
    v = x.var(dim=axis, keepdim=True, unbiased=False)
    return (x - m) / torch.sqrt(v + eps)
def _scatter_add(tgt, idx, src, axis=0):
    return tgt.clone().index_add_(axis, idx, src)
def _segment_sum(src, seg, n):
    out = torch.zeros((n,) + src.shape[1:], dtype=src.dtype)
    return out.index_add_(0, seg, src)
def _pad(x, pw):
    flat = tuple(v for pair in reversed(pw) for v in pair)
    return torch.nn.functional.pad(x, flat)

kernel_name = 'recurrent_scan__sliding_block_cached__dense_activation_relu__decode'

def setup_inputs():

    _w = (lambda a: (lambda t: t.to(torch.bfloat16) if t.is_floating_point() else t)(torch.as_tensor(a)))
    def _A_setup():
        B, Sq, D = 2, 1, 640
        Hq, Hkv, Sk, Dh = 32, 32, 8192, 128
        assert Hq % Hkv == 0, (Hq, Hkv)
        return {
            "x": _w((lambda *s: torch.randn(*s, dtype=torch.bfloat16) * 0.05)(B, Sq, D)),
            "k_cache": _w((lambda *s: torch.randn(*s, dtype=torch.bfloat16) * 1.6)(B, Hkv, Sk, Dh)),
            "v_cache": _w((lambda *s: torch.randn(*s, dtype=torch.bfloat16) * 0.2)(B, Hkv, Sk, Dh)),
            "wq": _w((lambda *s: torch.randn(*s, dtype=torch.bfloat16) * 1.6)(D, Hq * Dh) * (D ** -0.5)),
            "wo": _w((lambda *s: torch.randn(*s, dtype=torch.bfloat16) * 0.2)(Hq * Dh, D) * ((Hq * Dh) ** -0.5)),
        }
    _A_in = _A_setup()

    def _B_setup():
        B, S, D, Dff = 2, 1, 640, 1728
        return {
            "x": _w((lambda *s: torch.randn(*s, dtype=torch.bfloat16) * 0.05)(B, S, D)),
            "w1": _w((lambda *s: torch.randn(*s, dtype=torch.bfloat16) * 0.1)(D, Dff)),
            "w2": _w((lambda *s: torch.randn(*s, dtype=torch.bfloat16) * 0.1)(Dff, D)),
        }
    _B_in = _B_setup()

    return {
        "A_x": _A_in["x"],
        "A_k_cache": _A_in["k_cache"],
        "A_v_cache": _A_in["v_cache"],
        "A_wq": _A_in["wq"],
        "A_wo": _A_in["wo"],
        "B_x": _B_in["x"],
        "B_w1": _B_in["w1"],
        "B_w2": _B_in["w2"],
    }

def reference(A_x, A_k_cache, A_v_cache, A_wq, A_wo, B_x, B_w1, B_w2):
    def _A_ref(x, k_cache, v_cache, wq, wo):
        B, Sq, D = x.shape
        Hq, Dh = 32, 128
        Hkv, Sk = k_cache.shape[1], k_cache.shape[2]
        W = min(4096, max(256, Sk // 4))
        rep = Hq // Hkv
        q = (lambda x, *d: x.permute(*d))((x @ wq).reshape(B, Sq, Hq, Dh), 0, 2, 1, 3)
        k = (lambda x, n, axis: torch.repeat_interleave(x, n, dim=axis))(k_cache[:, :, Sk - W:, :], rep, axis=1)
        v = (lambda x, n, axis: torch.repeat_interleave(x, n, dim=axis))(v_cache[:, :, Sk - W:, :], rep, axis=1)
        scores = torch.einsum("bhqd,bhkd->bhqk", q, k) * (Dh ** -0.5)
        p = _softmax(scores, axis=-1)
        o = torch.einsum("bhqk,bhkd->bhqd", p, v)
        return (lambda x, *d: x.permute(*d))(o, 0, 2, 1, 3).reshape(B, Sq, Hq * Dh) @ wo

    def _B_ref(x, w1, w2):
        h = torch.einsum("bsd,df->bsf", x, w1)
        zero = torch.zeros_like(h)
        h = torch.maximum(h, zero)
        return torch.einsum("bsf,fd->bsd", h, w2)

    x = A_x
    xn = _layernorm(x, axis=-1)
    s = _A_ref(xn, A_k_cache, A_v_cache, A_wq, A_wo)
    g = _silu(_B_ref(xn, B_w1, B_w2))
    return x + s * g
```

```asm
; @launch grid=(256,1,1) block=(768,1,1) lds=18176
.amdgcn_target "amdgcn-amd-amdhsa--gfx950"
.text
.globl recurrent_scan__sliding_block_cached__dense_activation_relu__decode_kernel
.p2align 8
.type recurrent_scan__sliding_block_cached__dense_activation_relu__decode_kernel,@function
recurrent_scan__sliding_block_cached__dense_activation_relu__decode_kernel:
    s_cmp_ge_u32 s2, 256
    s_cbranch_scc1 L_end
    s_load_dwordx16 s[16:31], s[0:1], 0
    s_load_dwordx4 s[32:35], s[0:1], 64
    s_load_dwordx2 s[36:37], s[0:1], 80
    v_lshrrev_b32 v1, 6, v0
    v_and_b32 v0, 63, v0
    s_and_b32 s4, s2, 7
    s_lshr_b32 s5, s2, 6
    s_lshl_b32 s5, s5, 3
    s_or_b32 s4, s4, s5
    s_lshr_b32 s5, s2, 3
    s_and_b32 s5, s5, 7
    v_readfirstlane_b32 s3, v1
    s_lshl_b32 s6, s4, 3
    s_or_b32 s6, s6, s5
    s_lshr_b32 s7, s5, 2
    s_and_b32 s8, s5, 3
    s_mov_b32 s58, 8388608
    s_mov_b32 s59, 0x00020000
    s_cmp_lt_u32 s3, 4
    s_cbranch_scc1 L_aux
    s_sub_u32 s3, s3, 4
    s_lshl_b32 s9, s7, 5
    s_add_u32 s9, s9, s4
    s_lshl_b32 s9, s9, 21
    s_lshl_b32 s10, s8, 17
    s_add_u32 s9, s9, s10
    s_add_u32 s9, s9, 1572864
    s_lshl_b32 s10, s3, 14
    v_lshl_add_u32 v1, v0, 4, s10
    s_mul_i32 s11, s4, 3
    s_mul_i32 s12, s3, 5
    s_add_u32 s11, s11, s12
    s_lshl_b32 s11, s11, 10
    s_mov_b32 s42, 131072
    s_mov_b32 s43, 0x00020000
    s_mov_b32 s46, 131072
    s_mov_b32 s47, 0x00020000
    s_cmp_lt_u32 s4, 20
    s_cselect_b32 s13, 1, 0
    s_cmp_lt_u32 s3, 2
    s_cselect_b32 s13, s13, 0
    s_cmp_ge_u32 s4, 10
    s_cselect_b32 s14, 560, 0
    s_lshl_b32 s10, s4, 3
    s_add_u32 s14, s14, s10
    s_mul_i32 s10, s5, 80
    s_add_u32 s14, s14, s10
    s_lshl_b32 s10, s3, 2
    s_add_u32 s14, s14, s10
    v_and_b32 v6, 1, v0
    v_lshlrev_b32 v6, 1, v6
    v_lshrrev_b32 v7, 5, v0
    v_add3_u32 v6, v6, v7, s14
    v_lshlrev_b32 v2, 1, v6
    s_add_u32 s88, s11, 0
    s_and_b32 s88, s88, 0x3c00
    s_add_u32 s89, s11, 1024
    s_and_b32 s89, s89, 0x3c00
    s_add_u32 s90, s11, 2048
    s_and_b32 s90, s90, 0x3c00
    s_waitcnt lgkmcnt(0)
    s_add_u32 s40, s18, s9
    s_addc_u32 s41, s19, 0
    buffer_load_dwordx4 v[32:35], v1, s[40:43], s88 offen nt
    buffer_load_dwordx4 v[36:39], v1, s[40:43], s89 offen nt
    buffer_load_dwordx4 v[40:43], v1, s[40:43], s90 offen nt
    s_add_u32 s44, s20, s9
    s_addc_u32 s45, s21, 0
    s_mov_b32 s56, s36
    s_mov_b32 s57, s37
    s_mov_b32 s48, s16
    s_mov_b32 s49, s17
    s_movk_i32 s50, 2560
    s_mov_b32 s51, 0x00020000
    s_mov_b32 s64, s32
    s_mov_b32 s65, s33
    s_movk_i32 s66, 2560
    s_mov_b32 s67, 0x00020000
    s_add_u32 s16, s11, 0
    s_and_b32 s16, s16, 0x3c00
    s_add_u32 s17, s11, 1024
    s_and_b32 s17, s17, 0x3c00
    s_add_u32 s18, s11, 2048
    s_and_b32 s18, s18, 0x3c00
    s_add_u32 s19, s11, 3072
    s_and_b32 s19, s19, 0x3c00
    s_add_u32 s20, s11, 4096
    s_and_b32 s20, s20, 0x3c00
    s_add_u32 s21, s11, 5120
    s_and_b32 s21, s21, 0x3c00
    s_add_u32 s22, s11, 6144
    s_and_b32 s22, s22, 0x3c00
    s_add_u32 s23, s11, 7168
    s_and_b32 s23, s23, 0x3c00
    s_add_u32 s24, s11, 8192
    s_and_b32 s24, s24, 0x3c00
    s_add_u32 s25, s11, 9216
    s_and_b32 s25, s25, 0x3c00
    s_add_u32 s26, s11, 10240
    s_and_b32 s26, s26, 0x3c00
    s_add_u32 s27, s11, 11264
    s_and_b32 s27, s27, 0x3c00
    s_add_u32 s28, s11, 12288
    s_and_b32 s28, s28, 0x3c00
    s_add_u32 s29, s11, 13312
    s_and_b32 s29, s29, 0x3c00
    s_add_u32 s30, s11, 14336
    s_and_b32 s30, s30, 0x3c00
    s_add_u32 s31, s11, 15360
    s_and_b32 s31, s31, 0x3c00
    s_cmp_eq_u32 s13, 0
    s_cbranch_scc1 L_nox
    buffer_load_ushort v167, v2, s[48:51], 0 offen
L_nox:
    v_mov_b32 v7, 0
    s_barrier
    s_cmp_ge_u32 s3, 4
    s_waitcnt vmcnt(3)
    s_cbranch_scc1 L_wy3
    s_waitcnt vmcnt(2)
L_wy3:
    buffer_load_dwordx4 v[44:47], v1, s[40:43], s19 offen nt
    s_cmp_ge_u32 s3, 4
    s_waitcnt vmcnt(3)
    s_cbranch_scc1 L_wy4
    s_waitcnt vmcnt(2)
L_wy4:
    buffer_load_dwordx4 v[48:51], v1, s[40:43], s20 offen nt
    s_cmp_ge_u32 s3, 4
    s_waitcnt vmcnt(3)
    s_cbranch_scc1 L_wy5
    s_waitcnt vmcnt(2)
L_wy5:
    buffer_load_dwordx4 v[52:55], v1, s[40:43], s21 offen nt
    s_cmp_ge_u32 s3, 4
    s_waitcnt vmcnt(3)
    s_cbranch_scc1 L_wy6
    s_waitcnt vmcnt(2)
L_wy6:
    buffer_load_dwordx4 v[56:59], v1, s[40:43], s22 offen nt
    s_cmp_ge_u32 s3, 4
    s_waitcnt vmcnt(3)
    s_cbranch_scc1 L_wy7
    s_waitcnt vmcnt(2)
L_wy7:
    buffer_load_dwordx4 v[60:63], v1, s[40:43], s23 offen nt
    s_cmp_ge_u32 s3, 4
    s_waitcnt vmcnt(3)
    s_cbranch_scc1 L_wy8
    s_waitcnt vmcnt(2)
L_wy8:
    buffer_load_dwordx4 v[64:67], v1, s[40:43], s24 offen nt
    s_cmp_ge_u32 s3, 4
    s_waitcnt vmcnt(3)
    s_cbranch_scc1 L_wy9
    s_waitcnt vmcnt(2)
L_wy9:
    buffer_load_dwordx4 v[68:71], v1, s[40:43], s25 offen nt
    s_cmp_ge_u32 s3, 4
    s_waitcnt vmcnt(3)
    s_cbranch_scc1 L_wy10
    s_waitcnt vmcnt(2)
L_wy10:
    buffer_load_dwordx4 v[72:75], v1, s[40:43], s26 offen nt
    s_cmp_ge_u32 s3, 4
    s_waitcnt vmcnt(3)
    s_cbranch_scc1 L_wy11
    s_waitcnt vmcnt(2)
L_wy11:
    buffer_load_dwordx4 v[76:79], v1, s[40:43], s27 offen nt
    s_cmp_ge_u32 s3, 4
    s_waitcnt vmcnt(3)
    s_cbranch_scc1 L_wy12
    s_waitcnt vmcnt(2)
L_wy12:
    buffer_load_dwordx4 v[80:83], v1, s[40:43], s28 offen nt
    s_cmp_ge_u32 s3, 4
    s_waitcnt vmcnt(3)
    s_cbranch_scc1 L_wy13
    s_waitcnt vmcnt(2)
L_wy13:
    buffer_load_dwordx4 v[84:87], v1, s[40:43], s29 offen nt
    s_cmp_ge_u32 s3, 4
    s_waitcnt vmcnt(3)
    s_cbranch_scc1 L_wy14
    s_waitcnt vmcnt(2)
L_wy14:
    buffer_load_dwordx4 v[88:91], v1, s[40:43], s30 offen nt
    s_cmp_ge_u32 s3, 4
    s_waitcnt vmcnt(3)
    s_cbranch_scc1 L_wy15
    s_waitcnt vmcnt(2)
L_wy15:
    buffer_load_dwordx4 v[92:95], v1, s[40:43], s31 offen nt
    s_waitcnt vmcnt(6)
    buffer_load_dwordx4 v[96:99], v1, s[44:47], s16 offen nt
    s_waitcnt vmcnt(6)
    buffer_load_dwordx4 v[100:103], v1, s[44:47], s17 offen nt
    s_waitcnt vmcnt(6)
    buffer_load_dwordx4 v[104:107], v1, s[44:47], s18 offen nt
    s_waitcnt vmcnt(6)
    buffer_load_dwordx4 v[108:111], v1, s[44:47], s19 offen nt
    s_waitcnt vmcnt(6)
    buffer_load_dwordx4 v[112:115], v1, s[44:47], s20 offen nt
    s_waitcnt vmcnt(6)
    buffer_load_dwordx4 v[116:119], v1, s[44:47], s21 offen nt
    s_waitcnt vmcnt(6)
    buffer_load_dwordx4 v[120:123], v1, s[44:47], s22 offen nt
    ds_read_b32 v6, v7 offset:18052
    s_mov_b32 s9, 9
    s_waitcnt vmcnt(6)
    s_waitcnt lgkmcnt(0)
    v_readfirstlane_b32 s10, v6
    s_cmp_lg_u32 s10, 0
    s_cbranch_scc1 L_qready
    buffer_load_dwordx4 v[124:127], v1, s[44:47], s23 offen nt
    ds_read_b32 v6, v7 offset:18052
    s_mov_b32 s9, 8
    s_waitcnt vmcnt(6)
    s_waitcnt lgkmcnt(0)
    v_readfirstlane_b32 s10, v6
    s_cmp_lg_u32 s10, 0
    s_cbranch_scc1 L_qready
    buffer_load_dwordx4 v[128:131], v1, s[44:47], s24 offen nt
    ds_read_b32 v6, v7 offset:18052
    s_mov_b32 s9, 7
    s_waitcnt vmcnt(6)
    s_waitcnt lgkmcnt(0)
    v_readfirstlane_b32 s10, v6
    s_cmp_lg_u32 s10, 0
    s_cbranch_scc1 L_qready
    buffer_load_dwordx4 v[132:135], v1, s[44:47], s25 offen nt
    ds_read_b32 v6, v7 offset:18052
    s_mov_b32 s9, 6
    s_waitcnt vmcnt(6)
    s_waitcnt lgkmcnt(0)
    v_readfirstlane_b32 s10, v6
    s_cmp_lg_u32 s10, 0
    s_cbranch_scc1 L_qready
    buffer_load_dwordx4 v[136:139], v1, s[44:47], s26 offen nt
    ds_read_b32 v6, v7 offset:18052
    s_mov_b32 s9, 5
    s_waitcnt vmcnt(6)
    s_waitcnt lgkmcnt(0)
    v_readfirstlane_b32 s10, v6
    s_cmp_lg_u32 s10, 0
    s_cbranch_scc1 L_qready
    buffer_load_dwordx4 v[140:143], v1, s[44:47], s27 offen nt
    ds_read_b32 v6, v7 offset:18052
    s_mov_b32 s9, 4
    s_waitcnt vmcnt(6)
    s_waitcnt lgkmcnt(0)
    v_readfirstlane_b32 s10, v6
    s_cmp_lg_u32 s10, 0
    s_cbranch_scc1 L_qready
    buffer_load_dwordx4 v[144:147], v1, s[44:47], s28 offen nt
    ds_read_b32 v6, v7 offset:18052
    s_mov_b32 s9, 3
    s_waitcnt vmcnt(6)
    s_waitcnt lgkmcnt(0)
    v_readfirstlane_b32 s10, v6
    s_cmp_lg_u32 s10, 0
    s_cbranch_scc1 L_qready
    buffer_load_dwordx4 v[148:151], v1, s[44:47], s29 offen nt
    ds_read_b32 v6, v7 offset:18052
    s_mov_b32 s9, 2
    s_waitcnt vmcnt(6)
    s_waitcnt lgkmcnt(0)
    v_readfirstlane_b32 s10, v6
    s_cmp_lg_u32 s10, 0
    s_cbranch_scc1 L_qready
    buffer_load_dwordx4 v[152:155], v1, s[44:47], s30 offen nt
    ds_read_b32 v6, v7 offset:18052
    s_mov_b32 s9, 1
    s_waitcnt vmcnt(6)
    s_waitcnt lgkmcnt(0)
    v_readfirstlane_b32 s10, v6
    s_cmp_lg_u32 s10, 0
    s_cbranch_scc1 L_qready
    buffer_load_dwordx4 v[156:159], v1, s[44:47], s31 offen nt
    s_mov_b32 s9, 0
    s_waitcnt vmcnt(7)
    s_mov_b32 s12, 2000000
L_spin1:
    ds_read_b32 v6, v7 offset:18052
    s_waitcnt lgkmcnt(0)
    v_readfirstlane_b32 s10, v6
    s_cmp_ge_u32 s10, 1
    s_cbranch_scc1 L_spin1_done
    s_sleep 1
    s_sub_u32 s12, s12, 1
    s_cmp_lg_u32 s12, 0
    s_cbranch_scc1 L_spin1
L_spin1_done:
L_qready:
    v_and_b32 v6, 15, v0
    v_lshlrev_b32 v6, 4, v6
    ds_read_b128 v[2:5], v6 offset:6144
    ds_read_b64 v[8:9], v7 offset:10848
    ds_read_b32 v10, v7 offset:18084
    s_waitcnt lgkmcnt(0)
    v_readfirstlane_b32 s68, v8
    v_readfirstlane_b32 s69, v9
    v_readfirstlane_b32 s8, v10
    v_dot2_f32_bf16 v8, v32, v2, 0
    v_dot2_f32_bf16 v9, v36, v2, 0
    v_dot2_f32_bf16 v10, v40, v2, 0
    v_dot2_f32_bf16 v11, v44, v2, 0
    v_dot2_f32_bf16 v8, v33, v3, v8
    v_dot2_f32_bf16 v9, v37, v3, v9
    v_dot2_f32_bf16 v10, v41, v3, v10
    v_dot2_f32_bf16 v11, v45, v3, v11
    v_dot2_f32_bf16 v8, v34, v4, v8
    v_dot2_f32_bf16 v9, v38, v4, v9
    v_dot2_f32_bf16 v10, v42, v4, v10
    v_dot2_f32_bf16 v11, v46, v4, v11
    v_dot2_f32_bf16 v8, v35, v5, v8
    v_dot2_f32_bf16 v9, v39, v5, v9
    v_dot2_f32_bf16 v10, v43, v5, v10
    v_dot2_f32_bf16 v11, v47, v5, v11
    v_dot2_f32_bf16 v12, v48, v2, 0
    v_dot2_f32_bf16 v13, v52, v2, 0
    v_dot2_f32_bf16 v14, v56, v2, 0
    v_dot2_f32_bf16 v15, v60, v2, 0
    v_dot2_f32_bf16 v12, v49, v3, v12
    v_dot2_f32_bf16 v13, v53, v3, v13
    v_dot2_f32_bf16 v14, v57, v3, v14
    v_dot2_f32_bf16 v15, v61, v3, v15
    v_dot2_f32_bf16 v12, v50, v4, v12
    v_dot2_f32_bf16 v13, v54, v4, v13
    v_dot2_f32_bf16 v14, v58, v4, v14
    v_dot2_f32_bf16 v15, v62, v4, v15
    v_dot2_f32_bf16 v12, v51, v5, v12
    v_dot2_f32_bf16 v13, v55, v5, v13
    v_dot2_f32_bf16 v14, v59, v5, v14
    v_dot2_f32_bf16 v15, v63, v5, v15
    v_dot2_f32_bf16 v16, v64, v2, 0
    v_dot2_f32_bf16 v17, v68, v2, 0
    v_dot2_f32_bf16 v18, v72, v2, 0
    v_dot2_f32_bf16 v19, v76, v2, 0
    v_dot2_f32_bf16 v16, v65, v3, v16
    v_dot2_f32_bf16 v17, v69, v3, v17
    v_dot2_f32_bf16 v18, v73, v3, v18
    v_dot2_f32_bf16 v19, v77, v3, v19
    v_dot2_f32_bf16 v16, v66, v4, v16
    v_dot2_f32_bf16 v17, v70, v4, v17
    v_dot2_f32_bf16 v18, v74, v4, v18
    v_dot2_f32_bf16 v19, v78, v4, v19
    v_dot2_f32_bf16 v16, v67, v5, v16
    v_dot2_f32_bf16 v17, v71, v5, v17
    v_dot2_f32_bf16 v18, v75, v5, v18
    v_dot2_f32_bf16 v19, v79, v5, v19
    v_dot2_f32_bf16 v20, v80, v2, 0
    v_dot2_f32_bf16 v21, v84, v2, 0
    v_dot2_f32_bf16 v22, v88, v2, 0
    v_dot2_f32_bf16 v23, v92, v2, 0
    v_dot2_f32_bf16 v20, v81, v3, v20
    v_dot2_f32_bf16 v21, v85, v3, v21
    v_dot2_f32_bf16 v22, v89, v3, v22
    v_dot2_f32_bf16 v23, v93, v3, v23
    v_dot2_f32_bf16 v20, v82, v4, v20
    v_dot2_f32_bf16 v21, v86, v4, v21
    v_dot2_f32_bf16 v22, v90, v4, v22
    v_dot2_f32_bf16 v23, v94, v4, v23
    v_dot2_f32_bf16 v20, v83, v5, v20
    v_dot2_f32_bf16 v21, v87, v5, v21
    v_dot2_f32_bf16 v22, v91, v5, v22
    v_dot2_f32_bf16 v23, v95, v5, v23
    s_cmp_gt_u32 s9, 0
    s_cbranch_scc0 L_slot0_no
    s_waitcnt vmcnt(6)
    buffer_load_dwordx4 v[156:159], v1, s[44:47], s31 offen nt
    s_branch L_slot0_done
L_slot0_no:
    s_waitcnt vmcnt(0)
L_slot0_done:
    v_add_f32_dpp v8, v8, v8 quad_perm:[1,0,3,2] row_mask:0xf bank_mask:0xf
    v_add_f32_dpp v9, v9, v9 quad_perm:[1,0,3,2] row_mask:0xf bank_mask:0xf
    v_add_f32_dpp v10, v10, v10 quad_perm:[1,0,3,2] row_mask:0xf bank_mask:0xf
    v_add_f32_dpp v11, v11, v11 quad_perm:[1,0,3,2] row_mask:0xf bank_mask:0xf
    v_add_f32_dpp v12, v12, v12 quad_perm:[1,0,3,2] row_mask:0xf bank_mask:0xf
    v_add_f32_dpp v13, v13, v13 quad_perm:[1,0,3,2] row_mask:0xf bank_mask:0xf
    v_add_f32_dpp v14, v14, v14 quad_perm:[1,0,3,2] row_mask:0xf bank_mask:0xf
    v_add_f32_dpp v15, v15, v15 quad_perm:[1,0,3,2] row_mask:0xf bank_mask:0xf
    v_add_f32_dpp v16, v16, v16 quad_perm:[1,0,3,2] row_mask:0xf bank_mask:0xf
    v_add_f32_dpp v17, v17, v17 quad_perm:[1,0,3,2] row_mask:0xf bank_mask:0xf
    v_add_f32_dpp v18, v18, v18 quad_perm:[1,0,3,2] row_mask:0xf bank_mask:0xf
    v_add_f32_dpp v19, v19, v19 quad_perm:[1,0,3,2] row_mask:0xf bank_mask:0xf
    v_add_f32_dpp v20, v20, v20 quad_perm:[1,0,3,2] row_mask:0xf bank_mask:0xf
    v_add_f32_dpp v21, v21, v21 quad_perm:[1,0,3,2] row_mask:0xf bank_mask:0xf
    v_add_f32_dpp v22, v22, v22 quad_perm:[1,0,3,2] row_mask:0xf bank_mask:0xf
    v_add_f32_dpp v23, v23, v23 quad_perm:[1,0,3,2] row_mask:0xf bank_mask:0xf
    v_add_f32_dpp v8, v8, v8 quad_perm:[2,3,0,1] row_mask:0xf bank_mask:0xf
    v_add_f32_dpp v9, v9, v9 quad_perm:[2,3,0,1] row_mask:0xf bank_mask:0xf
    v_add_f32_dpp v10, v10, v10 quad_perm:[2,3,0,1] row_mask:0xf bank_mask:0xf
    v_add_f32_dpp v11, v11, v11 quad_perm:[2,3,0,1] row_mask:0xf bank_mask:0xf
    v_add_f32_dpp v12, v12, v12 quad_perm:[2,3,0,1] row_mask:0xf bank_mask:0xf
    v_add_f32_dpp v13, v13, v13 quad_perm:[2,3,0,1] row_mask:0xf bank_mask:0xf
    v_add_f32_dpp v14, v14, v14 quad_perm:[2,3,0,1] row_mask:0xf bank_mask:0xf
    v_add_f32_dpp v15, v15, v15 quad_perm:[2,3,0,1] row_mask:0xf bank_mask:0xf
    v_add_f32_dpp v16, v16, v16 quad_perm:[2,3,0,1] row_mask:0xf bank_mask:0xf
    v_add_f32_dpp v17, v17, v17 quad_perm:[2,3,0,1] row_mask:0xf bank_mask:0xf
    v_add_f32_dpp v18, v18, v18 quad_perm:[2,3,0,1] row_mask:0xf bank_mask:0xf
    v_add_f32_dpp v19, v19, v19 quad_perm:[2,3,0,1] row_mask:0xf bank_mask:0xf
    v_add_f32_dpp v20, v20, v20 quad_perm:[2,3,0,1] row_mask:0xf bank_mask:0xf
    v_add_f32_dpp v21, v21, v21 quad_perm:[2,3,0,1] row_mask:0xf bank_mask:0xf
    v_add_f32_dpp v22, v22, v22 quad_perm:[2,3,0,1] row_mask:0xf bank_mask:0xf
    v_add_f32_dpp v23, v23, v23 quad_perm:[2,3,0,1] row_mask:0xf bank_mask:0xf
    v_add_f32_dpp v8, v8, v8 row_half_mirror row_mask:0xf bank_mask:0xf
    v_add_f32_dpp v9, v9, v9 row_half_mirror row_mask:0xf bank_mask:0xf
    v_add_f32_dpp v10, v10, v10 row_half_mirror row_mask:0xf bank_mask:0xf
    v_add_f32_dpp v11, v11, v11 row_half_mirror row_mask:0xf bank_mask:0xf
    v_add_f32_dpp v12, v12, v12 row_half_mirror row_mask:0xf bank_mask:0xf
    v_add_f32_dpp v13, v13, v13 row_half_mirror row_mask:0xf bank_mask:0xf
    v_add_f32_dpp v14, v14, v14 row_half_mirror row_mask:0xf bank_mask:0xf
    v_add_f32_dpp v15, v15, v15 row_half_mirror row_mask:0xf bank_mask:0xf
    v_add_f32_dpp v16, v16, v16 row_half_mirror row_mask:0xf bank_mask:0xf
    v_add_f32_dpp v17, v17, v17 row_half_mirror row_mask:0xf bank_mask:0xf
    v_add_f32_dpp v18, v18, v18 row_half_mirror row_mask:0xf bank_mask:0xf
    v_add_f32_dpp v19, v19, v19 row_half_mirror row_mask:0xf bank_mask:0xf
    v_add_f32_dpp v20, v20, v20 row_half_mirror row_mask:0xf bank_mask:0xf
    v_add_f32_dpp v21, v21, v21 row_half_mirror row_mask:0xf bank_mask:0xf
    v_add_f32_dpp v22, v22, v22 row_half_mirror row_mask:0xf bank_mask:0xf
    v_add_f32_dpp v23, v23, v23 row_half_mirror row_mask:0xf bank_mask:0xf
    v_add_f32_dpp v8, v8, v8 row_mirror row_mask:0xf bank_mask:0xf
    v_add_f32_dpp v9, v9, v9 row_mirror row_mask:0xf bank_mask:0xf
    v_add_f32_dpp v10, v10, v10 row_mirror row_mask:0xf bank_mask:0xf
    v_add_f32_dpp v11, v11, v11 row_mirror row_mask:0xf bank_mask:0xf
    v_add_f32_dpp v12, v12, v12 row_mirror row_mask:0xf bank_mask:0xf
    v_add_f32_dpp v13, v13, v13 row_mirror row_mask:0xf bank_mask:0xf
    v_add_f32_dpp v14, v14, v14 row_mirror row_mask:0xf bank_mask:0xf
    v_add_f32_dpp v15, v15, v15 row_mirror row_mask:0xf bank_mask:0xf
    v_add_f32_dpp v16, v16, v16 row_mirror row_mask:0xf bank_mask:0xf
    v_add_f32_dpp v17, v17, v17 row_mirror row_mask:0xf bank_mask:0xf
    v_add_f32_dpp v18, v18, v18 row_mirror row_mask:0xf bank_mask:0xf
    v_add_f32_dpp v19, v19, v19 row_mirror row_mask:0xf bank_mask:0xf
    v_add_f32_dpp v20, v20, v20 row_mirror row_mask:0xf bank_mask:0xf
    v_add_f32_dpp v21, v21, v21 row_mirror row_mask:0xf bank_mask:0xf
    v_add_f32_dpp v22, v22, v22 row_mirror row_mask:0xf bank_mask:0xf
    v_add_f32_dpp v23, v23, v23 row_mirror row_mask:0xf bank_mask:0xf
    s_cmp_gt_u32 s9, 1
    s_cbranch_scc0 L_slot1_no
    s_waitcnt vmcnt(6)
    buffer_load_dwordx4 v[152:155], v1, s[44:47], s30 offen nt
    s_branch L_slot1_done
L_slot1_no:
    s_waitcnt vmcnt(0)
L_slot1_done:
    s_mov_b32 s14, 0x3db504f3
    s_mov_b32 s15, 0xffff0000
    v_cvt_pk_bf16_f32 v32, v8, v9
    v_cvt_pk_bf16_f32 v33, v10, v11
    v_cvt_pk_bf16_f32 v34, v12, v13
    v_cvt_pk_bf16_f32 v35, v14, v15
    v_cvt_pk_bf16_f32 v36, v16, v17
    v_cvt_pk_bf16_f32 v37, v18, v19
    v_cvt_pk_bf16_f32 v38, v20, v21
    v_cvt_pk_bf16_f32 v39, v22, v23
    v_lshlrev_b32 v8, 16, v32
    v_and_b32 v9, s15, v32
    v_lshlrev_b32 v10, 16, v33
    v_and_b32 v11, s15, v33
    v_lshlrev_b32 v12, 16, v34
    v_and_b32 v13, s15, v34
    v_lshlrev_b32 v14, 16, v35
    v_and_b32 v15, s15, v35
    v_lshlrev_b32 v16, 16, v36
    v_and_b32 v17, s15, v36
    v_lshlrev_b32 v18, 16, v37
    v_and_b32 v19, s15, v37
    v_lshlrev_b32 v20, 16, v38
    v_and_b32 v21, s15, v38
    v_lshlrev_b32 v22, 16, v39
    v_and_b32 v23, s15, v39
    v_mul_f32 v8, s14, v8
    v_mul_f32 v9, s14, v9
    v_mul_f32 v10, s14, v10
    v_mul_f32 v11, s14, v11
    v_mul_f32 v12, s14, v12
    v_mul_f32 v13, s14, v13
    v_mul_f32 v14, s14, v14
    v_mul_f32 v15, s14, v15
    v_mul_f32 v16, s14, v16
    v_mul_f32 v17, s14, v17
    v_mul_f32 v18, s14, v18
    v_mul_f32 v19, s14, v19
    v_mul_f32 v20, s14, v20
    v_mul_f32 v21, s14, v21
    v_mul_f32 v22, s14, v22
    v_mul_f32 v23, s14, v23
    v_cvt_pk_bf16_f32 v32, v8, v9
    v_cvt_pk_bf16_f32 v33, v10, v11
    v_cvt_pk_bf16_f32 v34, v12, v13
    v_cvt_pk_bf16_f32 v35, v14, v15
    v_cvt_pk_bf16_f32 v36, v16, v17
    v_cvt_pk_bf16_f32 v37, v18, v19
    v_cvt_pk_bf16_f32 v38, v20, v21
    v_cvt_pk_bf16_f32 v39, v22, v23
    v_lshlrev_b32 v8, 16, v32
    v_and_b32 v9, s15, v32
    v_lshlrev_b32 v10, 16, v33
    v_and_b32 v11, s15, v33
    v_lshlrev_b32 v12, 16, v34
    v_and_b32 v13, s15, v34
    v_lshlrev_b32 v14, 16, v35
    v_and_b32 v15, s15, v35
    v_lshlrev_b32 v16, 16, v36
    v_and_b32 v17, s15, v36
    v_lshlrev_b32 v18, 16, v37
    v_and_b32 v19, s15, v37
    v_lshlrev_b32 v20, 16, v38
    v_and_b32 v21, s15, v38
    v_lshlrev_b32 v22, 16, v39
    v_and_b32 v23, s15, v39
    v_max3_f32 v6, v8, v9, v10
    v_max3_f32 v6, v6, v11, v12
    v_max3_f32 v6, v6, v13, v14
    v_max3_f32 v6, v6, v15, v16
    v_max3_f32 v6, v6, v17, v18
    v_max3_f32 v6, v6, v19, v20
    v_max3_f32 v6, v6, v21, v22
    v_max_f32 v6, v6, v23
    s_nop 0
    v_readlane_b32 s60, v6, 0
    v_readlane_b32 s61, v6, 16
    v_readlane_b32 s62, v6, 32
    v_readlane_b32 s63, v6, 48
    v_mov_b32 v6, s60
    v_max_f32 v6, s61, v6
    v_max_f32 v6, s62, v6
    v_max_f32 v6, s63, v6
    s_cmp_gt_u32 s9, 2
    s_cbranch_scc0 L_slot2_no
    s_waitcnt vmcnt(6)
    buffer_load_dwordx4 v[148:151], v1, s[44:47], s29 offen nt
    s_branch L_slot2_done
L_slot2_no:
    s_waitcnt vmcnt(0)
L_slot2_done:
    s_mov_b32 s14, 0x3fb8aa3b
    v_sub_f32 v8, v8, v6
    v_sub_f32 v9, v9, v6
    v_sub_f32 v10, v10, v6
    v_sub_f32 v11, v11, v6
    v_sub_f32 v12, v12, v6
    v_sub_f32 v13, v13, v6
    v_sub_f32 v14, v14, v6
    v_sub_f32 v15, v15, v6
    v_sub_f32 v16, v16, v6
    v_sub_f32 v17, v17, v6
    v_sub_f32 v18, v18, v6
    v_sub_f32 v19, v19, v6
    v_sub_f32 v20, v20, v6
    v_sub_f32 v21, v21, v6
    v_sub_f32 v22, v22, v6
    v_sub_f32 v23, v23, v6
    v_mul_f32 v8, s14, v8
    v_mul_f32 v9, s14, v9
    v_mul_f32 v10, s14, v10
    v_mul_f32 v11, s14, v11
    v_mul_f32 v12, s14, v12
    v_mul_f32 v13, s14, v13
    v_mul_f32 v14, s14, v14
    v_mul_f32 v15, s14, v15
    v_mul_f32 v16, s14, v16
    v_mul_f32 v17, s14, v17
    v_mul_f32 v18, s14, v18
    v_mul_f32 v19, s14, v19
    v_mul_f32 v20, s14, v20
    v_mul_f32 v21, s14, v21
    v_mul_f32 v22, s14, v22
    v_mul_f32 v23, s14, v23
    v_exp_f32 v8, v8
    v_exp_f32 v9, v9
    v_exp_f32 v10, v10
    v_exp_f32 v11, v11
    v_exp_f32 v12, v12
    v_exp_f32 v13, v13
    v_exp_f32 v14, v14
    v_exp_f32 v15, v15
    v_exp_f32 v16, v16
    v_exp_f32 v17, v17
    v_exp_f32 v18, v18
    v_exp_f32 v19, v19
    v_exp_f32 v20, v20
    v_exp_f32 v21, v21
    v_exp_f32 v22, v22
    v_exp_f32 v23, v23
    v_mov_b32 v95, v167
    v_cvt_pk_bf16_f32 v32, v8, 0
    v_cvt_pk_bf16_f32 v33, v9, 0
    v_cvt_pk_bf16_f32 v34, v10, 0
    v_cvt_pk_bf16_f32 v35, v11, 0
    v_cvt_pk_bf16_f32 v36, v12, 0
    v_cvt_pk_bf16_f32 v37, v13, 0
    v_cvt_pk_bf16_f32 v38, v14, 0
    v_cvt_pk_bf16_f32 v39, v15, 0
    v_cvt_pk_bf16_f32 v40, v16, 0
    v_cvt_pk_bf16_f32 v41, v17, 0
    v_cvt_pk_bf16_f32 v42, v18, 0
    v_cvt_pk_bf16_f32 v43, v19, 0
    v_cvt_pk_bf16_f32 v44, v20, 0
    v_cvt_pk_bf16_f32 v45, v21, 0
    v_cvt_pk_bf16_f32 v46, v22, 0
    v_cvt_pk_bf16_f32 v47, v23, 0
    v_lshlrev_b32 v48, 16, v32
    v_lshlrev_b32 v49, 16, v33
    v_lshlrev_b32 v50, 16, v34
    v_lshlrev_b32 v51, 16, v35
    v_lshlrev_b32 v52, 16, v36
    v_lshlrev_b32 v53, 16, v37
    v_lshlrev_b32 v54, 16, v38
    v_lshlrev_b32 v55, 16, v39
    v_lshlrev_b32 v56, 16, v40
    v_lshlrev_b32 v57, 16, v41
    v_lshlrev_b32 v58, 16, v42
    v_lshlrev_b32 v59, 16, v43
    v_lshlrev_b32 v60, 16, v44
    v_lshlrev_b32 v61, 16, v45
    v_lshlrev_b32 v62, 16, v46
    v_lshlrev_b32 v63, 16, v47
    v_add_f32 v7, v8, v9
    v_add_f32 v7, v7, v10
    v_add_f32 v7, v7, v11
    v_add_f32 v7, v7, v12
    v_add_f32 v7, v7, v13
    v_add_f32 v7, v7, v14
    v_add_f32 v7, v7, v15
    v_add_f32 v7, v7, v16
    v_add_f32 v7, v7, v17
    v_add_f32 v7, v7, v18
    v_add_f32 v7, v7, v19
    v_add_f32 v7, v7, v20
    v_add_f32 v7, v7, v21
    v_add_f32 v7, v7, v22
    v_add_f32 v7, v7, v23
    s_nop 0
    v_readlane_b32 s60, v7, 0
    v_readlane_b32 s61, v7, 16
    v_readlane_b32 s62, v7, 32
    v_readlane_b32 s63, v7, 48
    v_mov_b32 v7, s60
    v_add_f32 v7, s61, v7
    v_add_f32 v7, s62, v7
    v_add_f32 v7, s63, v7
    s_lshl_b32 s10, s3, 2
    v_mov_b32 v8, s10
    v_mov_b32 v2, 0
    ds_write_b32 v8, v6 offset:10752
    ds_write_b32 v8, v7 offset:10784
    v_mov_b32 v9, 1
    s_mov_b64 exec, 1
    ds_add_u32 v2, v9 offset:18060
    s_mov_b64 exec, -1
    v_and_b32 v8, 15, v0
    v_lshlrev_b32 v8, 5, v8
    v_lshrrev_b32 v9, 4, v0
    v_lshl_add_u32 v8, v9, 3, v8
    s_lshl_b32 s10, s3, 9
    v_add_u32 v8, s10, v8
    v_lshlrev_b32 v10, 3, v0
    s_lshl_b32 s10, s6, 10
    s_add_u32 s10, s10, 786432
    v_lshl_add_u32 v11, v0, 4, s10
    v_mov_b32 v14, s68
    v_mov_b32 v15, s69
    v_dot2_f32_bf16 v24, v96, v32, 0
    v_dot2_f32_bf16 v25, v96, v48, 0
    v_dot2_f32_bf16 v26, v97, v32, 0
    v_dot2_f32_bf16 v27, v97, v48, 0
    v_dot2_f32_bf16 v28, v98, v32, 0
    v_dot2_f32_bf16 v29, v98, v48, 0
    v_dot2_f32_bf16 v30, v99, v32, 0
    v_dot2_f32_bf16 v31, v99, v48, 0
    v_dot2_f32_bf16 v24, v100, v33, v24
    v_dot2_f32_bf16 v25, v100, v49, v25
    v_dot2_f32_bf16 v26, v101, v33, v26
    v_dot2_f32_bf16 v27, v101, v49, v27
    v_dot2_f32_bf16 v28, v102, v33, v28
    v_dot2_f32_bf16 v29, v102, v49, v29
    v_dot2_f32_bf16 v30, v103, v33, v30
    v_dot2_f32_bf16 v31, v103, v49, v31
    v_dot2_f32_bf16 v24, v104, v34, v24
    v_dot2_f32_bf16 v25, v104, v50, v25
    v_dot2_f32_bf16 v26, v105, v34, v26
    v_dot2_f32_bf16 v27, v105, v50, v27
    v_dot2_f32_bf16 v28, v106, v34, v28
    v_dot2_f32_bf16 v29, v106, v50, v29
    v_dot2_f32_bf16 v30, v107, v34, v30
    v_dot2_f32_bf16 v31, v107, v50, v31
    s_cmp_gt_u32 s9, 3
    s_cbranch_scc0 L_slot3_no
    s_waitcnt vmcnt(6)
    buffer_load_dwordx4 v[144:147], v1, s[44:47], s28 offen nt
    s_branch L_slot3_done
L_slot3_no:
    s_waitcnt vmcnt(0)
L_slot3_done:
    v_dot2_f32_bf16 v24, v108, v35, v24
    v_dot2_f32_bf16 v25, v108, v51, v25
    v_dot2_f32_bf16 v26, v109, v35, v26
    v_dot2_f32_bf16 v27, v109, v51, v27
    v_dot2_f32_bf16 v28, v110, v35, v28
    v_dot2_f32_bf16 v29, v110, v51, v29
    v_dot2_f32_bf16 v30, v111, v35, v30
    v_dot2_f32_bf16 v31, v111, v51, v31
    s_cmp_gt_u32 s9, 4
    s_cbranch_scc0 L_slot4_no
    s_waitcnt vmcnt(6)
    buffer_load_dwordx4 v[140:143], v1, s[44:47], s27 offen nt
    s_branch L_slot4_done
L_slot4_no:
    s_waitcnt vmcnt(0)
L_slot4_done:
    v_dot2_f32_bf16 v24, v112, v36, v24
    v_dot2_f32_bf16 v25, v112, v52, v25
    v_dot2_f32_bf16 v26, v113, v36, v26
    v_dot2_f32_bf16 v27, v113, v52, v27
    v_dot2_f32_bf16 v28, v114, v36, v28
    v_dot2_f32_bf16 v29, v114, v52, v29
    v_dot2_f32_bf16 v30, v115, v36, v30
    v_dot2_f32_bf16 v31, v115, v52, v31
    s_cmp_gt_u32 s9, 5
    s_cbranch_scc0 L_slot5_no
    s_waitcnt vmcnt(6)
    buffer_load_dwordx4 v[136:139], v1, s[44:47], s26 offen nt
    s_branch L_slot5_done
L_slot5_no:
    s_waitcnt vmcnt(0)
L_slot5_done:
    v_dot2_f32_bf16 v24, v116, v37, v24
    v_dot2_f32_bf16 v25, v116, v53, v25
    v_dot2_f32_bf16 v26, v117, v37, v26
    v_dot2_f32_bf16 v27, v117, v53, v27
    v_dot2_f32_bf16 v28, v118, v37, v28
    v_dot2_f32_bf16 v29, v118, v53, v29
    v_dot2_f32_bf16 v30, v119, v37, v30
    v_dot2_f32_bf16 v31, v119, v53, v31
    s_cmp_gt_u32 s9, 6
    s_cbranch_scc0 L_slot6_no
    s_waitcnt vmcnt(6)
    buffer_load_dwordx4 v[132:135], v1, s[44:47], s25 offen nt
    s_branch L_slot6_done
L_slot6_no:
    s_waitcnt vmcnt(0)
L_slot6_done:
    v_dot2_f32_bf16 v24, v120, v38, v24
    v_dot2_f32_bf16 v25, v120, v54, v25
    v_dot2_f32_bf16 v26, v121, v38, v26
    v_dot2_f32_bf16 v27, v121, v54, v27
    v_dot2_f32_bf16 v28, v122, v38, v28
    v_dot2_f32_bf16 v29, v122, v54, v29
    v_dot2_f32_bf16 v30, v123, v38, v30
    v_dot2_f32_bf16 v31, v123, v54, v31
    s_cmp_gt_u32 s9, 7
    s_cbranch_scc0 L_slot7_no
    s_waitcnt vmcnt(6)
    buffer_load_dwordx4 v[128:131], v1, s[44:47], s24 offen nt
    s_branch L_slot7_done
L_slot7_no:
    s_waitcnt vmcnt(0)
L_slot7_done:
    v_dot2_f32_bf16 v24, v156, v47, v24
    v_dot2_f32_bf16 v25, v156, v63, v25
    v_dot2_f32_bf16 v26, v157, v47, v26
    v_dot2_f32_bf16 v27, v157, v63, v27
    v_dot2_f32_bf16 v28, v158, v47, v28
    v_dot2_f32_bf16 v29, v158, v63, v29
    v_dot2_f32_bf16 v30, v159, v47, v30
    v_dot2_f32_bf16 v31, v159, v63, v31
    s_cmp_gt_u32 s9, 8
    s_cbranch_scc0 L_slot8_no
    s_waitcnt vmcnt(6)
    buffer_load_dwordx4 v[124:127], v1, s[44:47], s23 offen nt
    s_branch L_slot8_done
L_slot8_no:
    s_waitcnt vmcnt(0)
L_slot8_done:
    v_dot2_f32_bf16 v24, v152, v46, v24
    v_dot2_f32_bf16 v25, v152, v62, v25
    v_dot2_f32_bf16 v26, v153, v46, v26
    v_dot2_f32_bf16 v27, v153, v62, v27
    v_dot2_f32_bf16 v28, v154, v46, v28
    v_dot2_f32_bf16 v29, v154, v62, v29
    v_dot2_f32_bf16 v30, v155, v46, v30
    v_dot2_f32_bf16 v31, v155, v62, v31
    s_waitcnt vmcnt(6)
    v_dot2_f32_bf16 v24, v148, v45, v24
    v_dot2_f32_bf16 v25, v148, v61, v25
    v_dot2_f32_bf16 v26, v149, v45, v26
    v_dot2_f32_bf16 v27, v149, v61, v27
    v_dot2_f32_bf16 v28, v150, v45, v28
    v_dot2_f32_bf16 v29, v150, v61, v29
    v_dot2_f32_bf16 v30, v151, v45, v30
    v_dot2_f32_bf16 v31, v151, v61, v31
    s_waitcnt vmcnt(5)
    v_dot2_f32_bf16 v24, v144, v44, v24
    v_dot2_f32_bf16 v25, v144, v60, v25
    v_dot2_f32_bf16 v26, v145, v44, v26
    v_dot2_f32_bf16 v27, v145, v60, v27
    v_dot2_f32_bf16 v28, v146, v44, v28
    v_dot2_f32_bf16 v29, v146, v60, v29
    v_dot2_f32_bf16 v30, v147, v44, v30
    v_dot2_f32_bf16 v31, v147, v60, v31
    s_waitcnt vmcnt(4)
    v_dot2_f32_bf16 v24, v140, v43, v24
    v_dot2_f32_bf16 v25, v140, v59, v25
    v_dot2_f32_bf16 v26, v141, v43, v26
    v_dot2_f32_bf16 v27, v141, v59, v27
    v_dot2_f32_bf16 v28, v142, v43, v28
    v_dot2_f32_bf16 v29, v142, v59, v29
    v_dot2_f32_bf16 v30, v143, v43, v30
    v_dot2_f32_bf16 v31, v143, v59, v31
    s_waitcnt vmcnt(3)
    v_dot2_f32_bf16 v24, v136, v42, v24
    v_dot2_f32_bf16 v25, v136, v58, v25
    v_dot2_f32_bf16 v26, v137, v42, v26
    v_dot2_f32_bf16 v27, v137, v58, v27
    v_dot2_f32_bf16 v28, v138, v42, v28
    v_dot2_f32_bf16 v29, v138, v58, v29
    v_dot2_f32_bf16 v30, v139, v42, v30
    v_dot2_f32_bf16 v31, v139, v58, v31
    s_waitcnt vmcnt(2)
    v_mov_b32 v16, 1
    s_mov_b64 exec, 1
    ds_add_u32 v2, v16 offset:18080
    s_mov_b64 exec, -1
    v_dot2_f32_bf16 v24, v132, v41, v24
    v_dot2_f32_bf16 v25, v132, v57, v25
    v_dot2_f32_bf16 v26, v133, v41, v26
    v_dot2_f32_bf16 v27, v133, v57, v27
    v_dot2_f32_bf16 v28, v134, v41, v28
    v_dot2_f32_bf16 v29, v134, v57, v29
    v_dot2_f32_bf16 v30, v135, v41, v30
    v_dot2_f32_bf16 v31, v135, v57, v31
    s_waitcnt vmcnt(1)
    s_mov_b32 s12, 2000000
L_spin2:
    ds_read_b32 v16, v2 offset:18064
    s_waitcnt lgkmcnt(0)
    v_readfirstlane_b32 s10, v16
    s_cmp_ge_u32 s10, 1
    s_cbranch_scc1 L_spin2_done
    s_sleep 1
    s_sub_u32 s12, s12, 1
    s_cmp_lg_u32 s12, 0
    s_cbranch_scc1 L_spin2
L_spin2_done:
    ds_read_b128 v[160:163], v2 offset:10816
    ds_read_b128 v[164:167], v2 offset:10832
    s_setprio 3
    v_dot2_f32_bf16 v24, v128, v40, v24
    v_dot2_f32_bf16 v25, v128, v56, v25
    v_dot2_f32_bf16 v26, v129, v40, v26
    v_dot2_f32_bf16 v27, v129, v56, v27
    v_dot2_f32_bf16 v28, v130, v40, v28
    v_dot2_f32_bf16 v29, v130, v56, v29
    v_dot2_f32_bf16 v30, v131, v40, v30
    v_dot2_f32_bf16 v31, v131, v56, v31
    s_waitcnt vmcnt(0)
    v_dot2_f32_bf16 v24, v124, v39, v24
    v_dot2_f32_bf16 v25, v124, v55, v25
    v_dot2_f32_bf16 v26, v125, v39, v26
    v_dot2_f32_bf16 v27, v125, v55, v27
    v_dot2_f32_bf16 v28, v126, v39, v28
    v_dot2_f32_bf16 v29, v126, v55, v29
    v_dot2_f32_bf16 v30, v127, v39, v30
    v_dot2_f32_bf16 v31, v127, v55, v31
    v_permlane32_swap_b32 v24, v28
    v_permlane32_swap_b32 v25, v29
    v_permlane32_swap_b32 v26, v30
    v_permlane32_swap_b32 v27, v31
    v_add_f32 v24, v24, v28
    v_add_f32 v25, v25, v29
    v_add_f32 v26, v26, v30
    v_add_f32 v27, v27, v31
    s_nop 0
    v_permlane16_swap_b32 v24, v26
    v_permlane16_swap_b32 v25, v27
    v_add_f32 v24, v24, v26
    v_add_f32 v25, v25, v27
    ds_write_b64 v8, v[24:25] offset:6656
    v_mov_b32 v16, 1
    s_mov_b64 exec, 1
    ds_add_rtn_u32 v16, v2, v16 offset:18068
    s_mov_b64 exec, -1
    s_waitcnt lgkmcnt(0)
    v_readfirstlane_b32 s10, v16
    s_cmp_eq_u32 s10, 7
    s_cbranch_scc0 L_nocomb
    ds_read_b64 v[32:33], v10 offset:6656
    ds_read_b64 v[34:35], v10 offset:7168
    ds_read_b64 v[36:37], v10 offset:7680
    ds_read_b64 v[38:39], v10 offset:8192
    ds_read_b64 v[40:41], v10 offset:8704
    ds_read_b64 v[42:43], v10 offset:9216
    ds_read_b64 v[44:45], v10 offset:9728
    ds_read_b64 v[46:47], v10 offset:10240
    s_waitcnt lgkmcnt(7)
    v_mul_f32 v12, v160, v32
    v_mul_f32 v13, v160, v33
    s_waitcnt lgkmcnt(6)
    v_fma_f32 v12, v161, v34, v12
    v_fma_f32 v13, v161, v35, v13
    s_waitcnt lgkmcnt(5)
    v_fma_f32 v12, v162, v36, v12
    v_fma_f32 v13, v162, v37, v13
    s_waitcnt lgkmcnt(4)
    v_fma_f32 v12, v163, v38, v12
    v_fma_f32 v13, v163, v39, v13
    s_waitcnt lgkmcnt(3)
    v_fma_f32 v12, v164, v40, v12
    v_fma_f32 v13, v164, v41, v13
    s_waitcnt lgkmcnt(2)
    v_fma_f32 v12, v165, v42, v12
    v_fma_f32 v13, v165, v43, v13
    s_waitcnt lgkmcnt(1)
    v_fma_f32 v12, v166, v44, v12
    v_fma_f32 v13, v166, v45, v13
    s_waitcnt lgkmcnt(0)
    v_fma_f32 v12, v167, v46, v12
    v_fma_f32 v13, v167, v47, v13
    s_mov_b32 s10, 4194304
    s_cmp_eq_u32 s8, 2
    s_cbranch_scc0 L_ds_h2_g
    buffer_store_dwordx4 v[12:15], v11, s[56:59], s10 offen
    s_branch L_ds_h2_d
L_ds_h2_g:
    buffer_store_dwordx4 v[12:15], v11, s[56:59], 0 offen sc1
L_ds_h2_d:
L_nocomb:
    s_cmp_eq_u32 s13, 0
    s_cbranch_scc1 L_sfin
    s_cmp_ge_u32 s4, 10
    s_cselect_b32 s9, 70, 0
    s_add_u32 s9, s9, s4
    s_mul_i32 s10, s5, 10
    s_add_u32 s9, s9, s10
    s_lshl_b32 s9, s9, 1
    s_add_u32 s9, s9, s3
    s_lshl_b32 s9, s9, 10
    s_add_u32 s9, s9, 1310720
    v_lshl_add_u32 v8, v0, 4, s9
    s_mov_b32 s11, 327680
    s_lshl_b32 s9, s4, 6
    s_mul_i32 s10, s5, 1280
    s_add_u32 s9, s9, s10
    s_lshl_b32 s10, s3, 5
    s_add_u32 s9, s9, s10
    s_add_u32 s9, s9, 1310720
    v_lshrrev_b32 v11, 1, v0
    v_mul_u32_u24 v11, 10240, v11
    v_and_b32 v10, 1, v0
    v_lshl_add_u32 v11, v10, 4, v11
    v_add_u32 v11, s9, v11
    s_mov_b32 s12, 20000
    s_mov_b64 s[38:39], -1
    buffer_load_dwordx4 v[32:35], v11, s[56:59], s11 offen sc1
L_pollY2:
    s_waitcnt vmcnt(0)
    v_cmp_eq_u64 s[70:71], v[34:35], s[68:69]
    s_and_b64 exec, s[70:71], s[38:39]
    v_mov_b32 v36, v32
    v_mov_b32 v37, v33
    s_andn2_b64 s[38:39], s[38:39], s[70:71]
    s_mov_b64 exec, s[38:39]
    s_cbranch_scc0 L_pollY2_done
    s_bcnt1_i32_b64 s10, s[38:39]
    s_cmp_lt_u32 s10, 1
    s_cbranch_scc1 L_fast3
    s_sleep 8
L_fast3:
    buffer_load_dwordx4 v[32:35], v11, s[56:59], s11 offen sc1
    s_mov_b64 exec, -1
    s_sub_u32 s12, s12, 1
    s_cmp_lg_u32 s12, 0
    s_cbranch_scc1 L_pollY2
L_pollY2_done:
    s_mov_b64 exec, -1
    s_cmp_ge_u32 s4, 10
    s_cselect_b32 s14, 560, 0
    s_lshl_b32 s10, s4, 3
    s_add_u32 s14, s14, s10
    s_mul_i32 s10, s5, 80
    s_add_u32 s14, s14, s10
    s_lshl_b32 s10, s3, 2
    s_add_u32 s14, s14, s10
    v_and_b32 v9, 1, v0
    v_lshlrev_b32 v9, 1, v9
    v_lshrrev_b32 v10, 5, v0
    v_add3_u32 v9, v9, v10, s14
    v_lshlrev_b32 v9, 1, v9
    v_add_f32_dpp v36, v36, v36 quad_perm:[2,3,0,1] row_mask:0xf bank_mask:0xf
    v_add_f32_dpp v37, v37, v37 quad_perm:[2,3,0,1] row_mask:0xf bank_mask:0xf
    s_nop 0
    v_add_f32_dpp v36, v36, v36 row_ror:4 row_mask:0xf bank_mask:0xf
    v_add_f32_dpp v37, v37, v37 row_ror:4 row_mask:0xf bank_mask:0xf
    s_nop 0
    v_add_f32_dpp v36, v36, v36 row_ror:8 row_mask:0xf bank_mask:0xf
    v_add_f32_dpp v37, v37, v37 row_ror:8 row_mask:0xf bank_mask:0xf
    s_nop 1
    v_permlane32_swap_b32 v36, v37
    v_add_f32 v36, v36, v37
    v_mov_b32 v37, v36
    s_nop 1
    v_permlane16_swap_b32 v36, v37
    v_add_f32 v36, v36, v37
    v_cvt_pk_bf16_f32 v36, v36, 0
    v_lshlrev_b32 v36, 16, v36
    s_mov_b32 s14, 0xbfb8aa3b
    v_mul_f32 v32, s14, v36
    v_exp_f32 v32, v32
    s_nop 0
    v_add_f32 v32, 1.0, v32
    v_rcp_f32 v32, v32
    s_nop 0
    v_mul_f32 v36, v36, v32
    v_cvt_pk_bf16_f32 v36, v36, 0
    v_lshlrev_b32 v36, 16, v36
    v_lshlrev_b32 v95, 16, v95
    s_mov_b32 s12, 2000000
L_spin4:
    ds_read_b32 v16, v2 offset:18076
    s_waitcnt lgkmcnt(0)
    v_readfirstlane_b32 s10, v16
    s_cmp_ge_u32 s10, 1
    s_cbranch_scc1 L_spin4_done
    s_sleep 1
    s_sub_u32 s12, s12, 1
    s_cmp_lg_u32 s12, 0
    s_cbranch_scc1 L_spin4
L_spin4_done:
    s_mov_b32 s12, 20000
    s_mov_b64 s[38:39], -1
    buffer_load_dwordx4 v[40:43], v11, s[56:59], 0 offen sc1
    s_sleep 6
    buffer_load_dwordx4 v[44:47], v11, s[56:59], 0 offen sc1
L_pollY1:
    s_waitcnt vmcnt(1)
    v_cmp_eq_u64 s[70:71], v[42:43], s[68:69]
    s_and_b64 exec, s[70:71], s[38:39]
    v_mov_b32 v38, v40
    v_mov_b32 v39, v41
    s_andn2_b64 s[38:39], s[38:39], s[70:71]
    s_mov_b64 exec, s[38:39]
    s_cbranch_scc0 L_pollY1_done
    s_bcnt1_i32_b64 s10, s[38:39]
    s_cmp_lt_u32 s10, 8
    s_cbranch_scc1 L_fast5
    s_sleep 8
L_fast5:
    buffer_load_dwordx4 v[40:43], v11, s[56:59], 0 offen sc1
    s_mov_b64 exec, -1
    s_waitcnt vmcnt(1)
    v_cmp_eq_u64 s[70:71], v[46:47], s[68:69]
    s_and_b64 exec, s[70:71], s[38:39]
    v_mov_b32 v38, v44
    v_mov_b32 v39, v45
    s_andn2_b64 s[38:39], s[38:39], s[70:71]
    s_mov_b64 exec, s[38:39]
    s_cbranch_scc0 L_pollY1_done
    s_bcnt1_i32_b64 s10, s[38:39]
    s_cmp_lt_u32 s10, 8
    s_cbranch_scc1 L_fast6
    s_sleep 8
L_fast6:
    buffer_load_dwordx4 v[44:47], v11, s[56:59], 0 offen sc1
    s_mov_b64 exec, -1
    s_sub_u32 s12, s12, 1
    s_cmp_lg_u32 s12, 0
    s_cbranch_scc1 L_pollY1
L_pollY1_done:
    s_mov_b64 exec, -1
    v_add_f32_dpp v38, v38, v38 quad_perm:[2,3,0,1] row_mask:0xf bank_mask:0xf
    v_add_f32_dpp v39, v39, v39 quad_perm:[2,3,0,1] row_mask:0xf bank_mask:0xf
    s_nop 0
    v_add_f32_dpp v38, v38, v38 row_ror:4 row_mask:0xf bank_mask:0xf
    v_add_f32_dpp v39, v39, v39 row_ror:4 row_mask:0xf bank_mask:0xf
    s_nop 0
    v_add_f32_dpp v38, v38, v38 row_ror:8 row_mask:0xf bank_mask:0xf
    v_add_f32_dpp v39, v39, v39 row_ror:8 row_mask:0xf bank_mask:0xf
    s_nop 1
    v_permlane32_swap_b32 v38, v39
    v_add_f32 v38, v38, v39
    v_mov_b32 v39, v38
    s_nop 1
    v_permlane16_swap_b32 v38, v39
    v_add_f32 v38, v38, v39
    v_cvt_pk_bf16_f32 v38, v38, 0
    v_lshlrev_b32 v38, 16, v38
    v_mul_f32 v38, v38, v36
    v_cvt_pk_bf16_f32 v38, v38, 0
    v_lshlrev_b32 v38, 16, v38
    v_add_f32 v38, v95, v38
    v_cvt_pk_bf16_f32 v38, v38, 0
    s_mov_b32 s10, 3
    s_mov_b32 s11, 3
    s_mov_b64 exec, s[10:11]
    buffer_store_short v38, v9, s[64:67], 0 offen
    s_or_b32 s10, s6, s3
    s_cmp_lg_u32 s10, 0
    s_cbranch_scc1 L_noep
    s_mov_b64 exec, 1
    v_mov_b32 v10, 2031616
    v_mov_b32 v11, s68
    buffer_store_dword v11, v10, s[56:59], 0 offen sc1
L_noep:
    s_mov_b64 exec, -1
L_sfin:
    s_add_u32 s3, s3, 4
    s_branch L_fin
L_aux:
    s_setprio 3
    s_cmp_lg_u32 s3, 0
    s_cbranch_scc1 L_noclr
    v_mov_b32 v4, 0
    v_mov_b32 v5, 0
    v_mov_b32 v6, 0
    v_mov_b32 v7, 0
    ds_write_b128 v4, v[4:7] offset:18048
    ds_write_b128 v4, v[4:7] offset:18064
    ds_write_b128 v4, v[4:7] offset:18080
L_noclr:
    v_lshlrev_b32 v2, 4, v0
    v_lshlrev_b32 v3, 2, v0
    v_mov_b32 v30, 2031616
    s_mul_i32 s9, s5, 80
    s_mul_i32 s10, s3, 20
    s_add_u32 s9, s9, s10
    v_lshrrev_b32 v10, 4, v0
    v_and_b32 v11, 15, v0
    v_add_u32 v74, s9, v10
    v_lshlrev_b32 v75, 1, v74
    v_lshlrev_b32 v65, 13, v74
    v_lshl_add_u32 v65, v11, 4, v65
    s_lshl_b32 s10, s4, 8
    v_add_u32 v65, s10, v65
    s_mov_b32 s11, s4
    s_cmp_eq_u32 s4, 27
    s_cselect_b32 s11, 21, s11
    s_cmp_eq_u32 s4, 21
    s_cselect_b32 s11, 27, s11
    s_cmp_eq_u32 s4, 30
    s_cselect_b32 s11, 23, s11
    s_cmp_eq_u32 s4, 23
    s_cselect_b32 s11, 30, s11
    s_cmp_ge_u32 s11, 27
    s_cselect_b32 s13, 1073741824, 0
    s_movk_i32 s10, 3456
    v_mul_lo_u32 v66, v74, s10
    v_lshl_add_u32 v66, v11, 3, v66
    s_lshl_b32 s10, s11, 7
    s_add_u32 s10, s10, s13
    v_add_u32 v66, s10, v66
    s_mov_b32 s89, 32768
    s_mov_b32 s93, 13824
    s_mov_b32 s90, 65536
    s_mov_b32 s94, 27648
    s_mov_b32 s91, 98304
    s_mov_b32 s95, 41472
    s_mov_b32 s92, 131072
    s_mov_b32 s88, 55296
    s_waitcnt lgkmcnt(0)
    s_mov_b32 s56, s36
    s_mov_b32 s57, s37
    s_mov_b32 s40, s16
    s_mov_b32 s41, s17
    s_mov_b32 s42, 2560
    s_mov_b32 s43, 0x00020000
    buffer_load_dword v30, v30, s[56:59], 0 offen sc1
    buffer_load_dwordx4 v[4:7], v2, s[40:43], 0 offen
    buffer_load_dword v8, v3, s[40:43], 0 offen offset:1024
    buffer_load_dwordx4 v[12:15], v2, s[40:43], 0 offen offset:1280
    buffer_load_dword v16, v3, s[40:43], 0 offen offset:2304
    s_mov_b32 s44, s22
    s_mov_b32 s45, s23
    s_mov_b32 s46, 5242880
    s_mov_b32 s47, 0x00020000
    buffer_load_dwordx4 v[32:35], v65, s[44:47], 0 offen nt
    buffer_load_dwordx4 v[36:39], v65, s[44:47], s89 offen nt
    buffer_load_dwordx4 v[40:43], v65, s[44:47], s90 offen nt
    buffer_load_dwordx4 v[44:47], v65, s[44:47], s91 offen nt
    buffer_load_dwordx4 v[48:51], v65, s[44:47], s92 offen nt
    s_mov_b32 s48, s28
    s_mov_b32 s49, s29
    s_mov_b32 s50, 2211840
    s_mov_b32 s51, 0x00020000
    buffer_load_dwordx2 v[52:53], v66, s[48:51], 0 offen nt
    buffer_load_dwordx2 v[54:55], v66, s[48:51], s93 offen nt
    buffer_load_dwordx2 v[56:57], v66, s[48:51], s94 offen nt
    buffer_load_dwordx2 v[58:59], v66, s[48:51], s95 offen nt
    buffer_load_dwordx2 v[60:61], v66, s[48:51], s88 offen nt
    buffer_load_ushort v20, v75, s[40:43], 0 offen offset:0
    buffer_load_ushort v21, v75, s[40:43], 0 offen offset:1280
    buffer_load_ushort v22, v75, s[40:43], 0 offen offset:8
    buffer_load_ushort v23, v75, s[40:43], 0 offen offset:1288
    buffer_load_ushort v24, v75, s[40:43], 0 offen offset:16
    buffer_load_ushort v25, v75, s[40:43], 0 offen offset:1296
    buffer_load_ushort v26, v75, s[40:43], 0 offen offset:24
    buffer_load_ushort v27, v75, s[40:43], 0 offen offset:1304
    buffer_load_ushort v28, v75, s[40:43], 0 offen offset:32
    buffer_load_ushort v29, v75, s[40:43], 0 offen offset:1312
    s_waitcnt lgkmcnt(0)
    s_barrier
    v_mov_b32 v69, 0
    v_mov_b32 v70, 1073741824
    v_cmp_lt_u32 vcc, 9, v11
    s_nop 1
    v_cndmask_b32 v69, v69, v70, vcc
    v_lshl_add_u32 v69, v11, 4, v69
    s_mul_i32 s10, s5, 160
    v_add_u32 v69, s10, v69
    s_movk_i32 s14, 1280
    s_mov_b32 s10, s4
    s_cmp_eq_u32 s4, 27
    s_cselect_b32 s10, 21, s10
    s_cmp_eq_u32 s4, 21
    s_cselect_b32 s10, 27, s10
    s_cmp_eq_u32 s4, 30
    s_cselect_b32 s10, 23, s10
    s_cmp_eq_u32 s4, 23
    s_cselect_b32 s10, 30, s10
    s_lshl_b32 s10, s10, 6
    s_lshl_b32 s11, s3, 4
    s_add_u32 s10, s10, s11
    v_lshl_add_u32 v67, v10, 2, s10
    v_mul_lo_u32 v67, v67, s14
    v_add_u32 v67, v69, v67
    v_add_u32 v67, s13, v67
    s_lshl_b32 s10, s4, 7
    s_lshl_b32 s11, s3, 5
    s_add_u32 s10, s10, s11
    v_lshl_add_u32 v68, v10, 3, s10
    v_mul_lo_u32 v68, v68, s14
    v_add_u32 v68, v69, v68
    s_movk_i32 s12, 5120
    s_mov_b32 s52, s30
    s_mov_b32 s53, s31
    s_mov_b32 s54, 2211840
    s_mov_b32 s55, 0x00020000
    buffer_load_dwordx4 v[120:123], v67, s[52:55], 0 offen offset:0 nt
    buffer_load_dwordx4 v[124:127], v67, s[52:55], 0 offen offset:1280 nt
    buffer_load_dwordx4 v[128:131], v67, s[52:55], 0 offen offset:2560 nt
    buffer_load_dwordx4 v[132:135], v67, s[52:55], 0 offen offset:3840 nt
    s_mov_b32 s60, s24
    s_mov_b32 s61, s25
    s_mov_b32 s62, 5242880
    s_mov_b32 s63, 0x00020000
    buffer_load_dwordx4 v[136:139], v68, s[60:63], 0 offen offset:0 nt
    buffer_load_dwordx4 v[140:143], v68, s[60:63], 0 offen offset:1280 nt
    buffer_load_dwordx4 v[144:147], v68, s[60:63], 0 offen offset:2560 nt
    buffer_load_dwordx4 v[148:151], v68, s[60:63], 0 offen offset:3840 nt
    buffer_load_dwordx4 v[152:155], v68, s[60:63], s12 offen offset:0 nt
    buffer_load_dwordx4 v[156:159], v68, s[60:63], s12 offen offset:1280 nt
    buffer_load_dwordx4 v[160:163], v68, s[60:63], s12 offen offset:2560 nt
    buffer_load_dwordx4 v[164:167], v68, s[60:63], s12 offen offset:3840 nt
    s_waitcnt vmcnt(32)
    v_readfirstlane_b32 s68, v30
    s_mov_b32 s15, 0xffff0000
    s_add_u32 s68, s68, 1
    s_xor_b32 s69, s68, 0x9e3779b9
    v_lshlrev_b32 v76, 16, v4
    v_and_b32 v77, s15, v4
    v_lshlrev_b32 v78, 16, v5
    v_and_b32 v79, s15, v5
    v_lshlrev_b32 v80, 16, v6
    v_and_b32 v81, s15, v6
    v_lshlrev_b32 v82, 16, v7
    v_and_b32 v83, s15, v7
    v_lshlrev_b32 v84, 16, v8
    v_and_b32 v85, s15, v8
    v_lshlrev_b32 v86, 16, v12
    v_and_b32 v87, s15, v12
    v_lshlrev_b32 v88, 16, v13
    v_and_b32 v89, s15, v13
    v_lshlrev_b32 v90, 16, v14
    v_and_b32 v91, s15, v14
    v_lshlrev_b32 v92, 16, v15
    v_and_b32 v93, s15, v15
    v_lshlrev_b32 v94, 16, v16
    v_and_b32 v95, s15, v16
    v_add_f32 v4, v76, v77
    v_add_f32 v5, v86, v87
    v_add_f32 v4, v4, v78
    v_add_f32 v5, v5, v88
    v_add_f32 v4, v4, v79
    v_add_f32 v5, v5, v89
    v_add_f32 v4, v4, v80
    v_add_f32 v5, v5, v90
    v_add_f32 v4, v4, v81
    v_add_f32 v5, v5, v91
    v_add_f32 v4, v4, v82
    v_add_f32 v5, v5, v92
    v_add_f32 v4, v4, v83
    v_add_f32 v5, v5, v93
    v_add_f32 v4, v4, v84
    v_add_f32 v5, v5, v94
    v_add_f32 v4, v4, v85
    v_add_f32 v5, v5, v95
    s_nop 0
    v_add_f32_dpp v4, v4, v4 quad_perm:[1,0,3,2] row_mask:0xf bank_mask:0xf
    v_add_f32_dpp v5, v5, v5 quad_perm:[1,0,3,2] row_mask:0xf bank_mask:0xf
    s_nop 0
    v_add_f32_dpp v4, v4, v4 quad_perm:[2,3,0,1] row_mask:0xf bank_mask:0xf
    v_add_f32_dpp v5, v5, v5 quad_perm:[2,3,0,1] row_mask:0xf bank_mask:0xf
    s_nop 0
    v_add_f32_dpp v4, v4, v4 row_half_mirror row_mask:0xf bank_mask:0xf
    v_add_f32_dpp v5, v5, v5 row_half_mirror row_mask:0xf bank_mask:0xf
    s_nop 0
    v_add_f32_dpp v4, v4, v4 row_mirror row_mask:0xf bank_mask:0xf
    v_add_f32_dpp v5, v5, v5 row_mirror row_mask:0xf bank_mask:0xf
    v_readlane_b32 s88, v4, 0
    v_readlane_b32 s92, v5, 0
    v_readlane_b32 s89, v4, 16
    v_readlane_b32 s93, v5, 16
    v_readlane_b32 s90, v4, 32
    v_readlane_b32 s94, v5, 32
    v_readlane_b32 s91, v4, 48
    v_readlane_b32 s95, v5, 48
    v_mov_b32 v4, s88
    v_mov_b32 v5, s92
    v_add_f32 v4, s89, v4
    v_add_f32 v5, s93, v5
    v_add_f32 v4, s90, v4
    v_add_f32 v5, s94, v5
    v_add_f32 v4, s91, v4
    v_add_f32 v5, s95, v5
    s_mov_b32 s14, 0x3acccccd
    v_mul_f32 v4, s14, v4
    v_mul_f32 v5, s14, v5
    v_sub_f32 v76, v76, v4
    v_sub_f32 v77, v77, v4
    v_sub_f32 v78, v78, v4
    v_sub_f32 v79, v79, v4
    v_sub_f32 v80, v80, v4
    v_sub_f32 v81, v81, v4
    v_sub_f32 v82, v82, v4
    v_sub_f32 v83, v83, v4
    v_sub_f32 v84, v84, v4
    v_sub_f32 v85, v85, v4
    v_sub_f32 v86, v86, v5
    v_sub_f32 v87, v87, v5
    v_sub_f32 v88, v88, v5
    v_sub_f32 v89, v89, v5
    v_sub_f32 v90, v90, v5
    v_sub_f32 v91, v91, v5
    v_sub_f32 v92, v92, v5
    v_sub_f32 v93, v93, v5
    v_sub_f32 v94, v94, v5
    v_sub_f32 v95, v95, v5
    v_mul_f32 v6, v76, v76
    v_mul_f32 v7, v86, v86
    v_fma_f32 v6, v77, v77, v6
    v_fma_f32 v7, v87, v87, v7
    v_fma_f32 v6, v78, v78, v6
    v_fma_f32 v7, v88, v88, v7
    v_fma_f32 v6, v79, v79, v6
    v_fma_f32 v7, v89, v89, v7
    v_fma_f32 v6, v80, v80, v6
    v_fma_f32 v7, v90, v90, v7
    v_fma_f32 v6, v81, v81, v6
    v_fma_f32 v7, v91, v91, v7
    v_fma_f32 v6, v82, v82, v6
    v_fma_f32 v7, v92, v92, v7
    v_fma_f32 v6, v83, v83, v6
    v_fma_f32 v7, v93, v93, v7
    v_fma_f32 v6, v84, v84, v6
    v_fma_f32 v7, v94, v94, v7
    v_fma_f32 v6, v85, v85, v6
    v_fma_f32 v7, v95, v95, v7
    s_nop 0
    v_add_f32_dpp v6, v6, v6 quad_perm:[1,0,3,2] row_mask:0xf bank_mask:0xf
    v_add_f32_dpp v7, v7, v7 quad_perm:[1,0,3,2] row_mask:0xf bank_mask:0xf
    s_nop 0
    v_add_f32_dpp v6, v6, v6 quad_perm:[2,3,0,1] row_mask:0xf bank_mask:0xf
    v_add_f32_dpp v7, v7, v7 quad_perm:[2,3,0,1] row_mask:0xf bank_mask:0xf
    s_nop 0
    v_add_f32_dpp v6, v6, v6 row_half_mirror row_mask:0xf bank_mask:0xf
    v_add_f32_dpp v7, v7, v7 row_half_mirror row_mask:0xf bank_mask:0xf
    s_nop 0
    v_add_f32_dpp v6, v6, v6 row_mirror row_mask:0xf bank_mask:0xf
    v_add_f32_dpp v7, v7, v7 row_mirror row_mask:0xf bank_mask:0xf
    v_readlane_b32 s88, v6, 0
    v_readlane_b32 s92, v7, 0
    v_readlane_b32 s89, v6, 16
    v_readlane_b32 s93, v7, 16
    v_readlane_b32 s90, v6, 32
    v_readlane_b32 s94, v7, 32
    v_readlane_b32 s91, v6, 48
    v_readlane_b32 s95, v7, 48
    v_mov_b32 v6, s88
    v_mov_b32 v7, s92
    v_add_f32 v6, s89, v6
    v_add_f32 v7, s93, v7
    v_add_f32 v6, s90, v6
    v_add_f32 v7, s94, v7
    v_add_f32 v6, s91, v6
    v_add_f32 v7, s95, v7
    v_mul_f32 v6, s14, v6
    v_mul_f32 v7, s14, v7
    v_cvt_pk_bf16_f32 v8, v4, v5
    v_cvt_pk_bf16_f32 v9, v6, v7
    v_lshlrev_b32 v4, 16, v8
    v_and_b32 v5, s15, v8
    v_lshlrev_b32 v6, 16, v9
    v_and_b32 v7, s15, v9
    s_mov_b32 s14, 0x3727c5ac
    v_add_f32 v6, s14, v6
    v_add_f32 v7, s14, v7
    v_cvt_pk_bf16_f32 v9, v6, v7
    v_lshlrev_b32 v6, 16, v9
    v_and_b32 v7, s15, v9
    v_sqrt_f32 v6, v6
    v_sqrt_f32 v7, v7
    s_nop 0
    v_cvt_pk_bf16_f32 v9, v6, v7
    v_lshlrev_b32 v6, 16, v9
    v_and_b32 v7, s15, v9
    v_rcp_f32 v6, v6
    v_rcp_f32 v7, v7
    s_waitcnt vmcnt(12)
    v_lshlrev_b32 v20, 16, v20
    v_lshlrev_b32 v21, 16, v21
    v_lshlrev_b32 v22, 16, v22
    v_lshlrev_b32 v23, 16, v23
    v_lshlrev_b32 v24, 16, v24
    v_lshlrev_b32 v25, 16, v25
    v_lshlrev_b32 v26, 16, v26
    v_lshlrev_b32 v27, 16, v27
    v_lshlrev_b32 v28, 16, v28
    v_lshlrev_b32 v29, 16, v29
    v_sub_f32 v20, v20, v4
    v_sub_f32 v21, v21, v5
    v_sub_f32 v22, v22, v4
    v_sub_f32 v23, v23, v5
    v_sub_f32 v24, v24, v4
    v_sub_f32 v25, v25, v5
    v_sub_f32 v26, v26, v4
    v_sub_f32 v27, v27, v5
    v_sub_f32 v28, v28, v4
    v_sub_f32 v29, v29, v5
    v_cvt_pk_bf16_f32 v20, v20, 0
    v_cvt_pk_bf16_f32 v21, v21, 0
    v_cvt_pk_bf16_f32 v22, v22, 0
    v_cvt_pk_bf16_f32 v23, v23, 0
    v_cvt_pk_bf16_f32 v24, v24, 0
    v_cvt_pk_bf16_f32 v25, v25, 0
    v_cvt_pk_bf16_f32 v26, v26, 0
    v_cvt_pk_bf16_f32 v27, v27, 0
    v_cvt_pk_bf16_f32 v28, v28, 0
    v_cvt_pk_bf16_f32 v29, v29, 0
    v_lshlrev_b32 v20, 16, v20
    v_lshlrev_b32 v21, 16, v21
    v_lshlrev_b32 v22, 16, v22
    v_lshlrev_b32 v23, 16, v23
    v_lshlrev_b32 v24, 16, v24
    v_lshlrev_b32 v25, 16, v25
    v_lshlrev_b32 v26, 16, v26
    v_lshlrev_b32 v27, 16, v27
    v_lshlrev_b32 v28, 16, v28
    v_lshlrev_b32 v29, 16, v29
    v_mul_f32 v20, v20, v6
    v_mul_f32 v21, v21, v7
    v_mul_f32 v22, v22, v6
    v_mul_f32 v23, v23, v7
    v_mul_f32 v24, v24, v6
    v_mul_f32 v25, v25, v7
    v_mul_f32 v26, v26, v6
    v_mul_f32 v27, v27, v7
    v_mul_f32 v28, v28, v6
    v_mul_f32 v29, v29, v7
    v_cvt_pk_bf16_f32 v20, v20, 0
    v_cvt_pk_bf16_f32 v21, v21, 0
    v_cvt_pk_bf16_f32 v22, v22, 0
    v_cvt_pk_bf16_f32 v23, v23, 0
    v_cvt_pk_bf16_f32 v24, v24, 0
    v_cvt_pk_bf16_f32 v25, v25, 0
    v_cvt_pk_bf16_f32 v26, v26, 0
    v_cvt_pk_bf16_f32 v27, v27, 0
    v_cvt_pk_bf16_f32 v28, v28, 0
    v_cvt_pk_bf16_f32 v29, v29, 0
    v_lshlrev_b32 v76, 16, v20
    v_lshlrev_b32 v77, 16, v21
    v_lshlrev_b32 v78, 16, v22
    v_lshlrev_b32 v79, 16, v23
    v_lshlrev_b32 v80, 16, v24
    v_lshlrev_b32 v81, 16, v25
    v_lshlrev_b32 v82, 16, v26
    v_lshlrev_b32 v83, 16, v27
    v_lshlrev_b32 v84, 16, v28
    v_lshlrev_b32 v85, 16, v29
    v_dot2_f32_bf16 v96, v32, v20, 0
    v_dot2_f32_bf16 v97, v32, v76, 0
    v_dot2_f32_bf16 v98, v33, v20, 0
    v_dot2_f32_bf16 v99, v33, v76, 0
    v_dot2_f32_bf16 v100, v34, v20, 0
    v_dot2_f32_bf16 v101, v34, v76, 0
    v_dot2_f32_bf16 v102, v35, v20, 0
    v_dot2_f32_bf16 v103, v35, v76, 0
    v_dot2_f32_bf16 v104, v32, v21, 0
    v_dot2_f32_bf16 v105, v32, v77, 0
    v_dot2_f32_bf16 v106, v33, v21, 0
    v_dot2_f32_bf16 v107, v33, v77, 0
    v_dot2_f32_bf16 v108, v34, v21, 0
    v_dot2_f32_bf16 v109, v34, v77, 0
    v_dot2_f32_bf16 v110, v35, v21, 0
    v_dot2_f32_bf16 v111, v35, v77, 0
    v_dot2_f32_bf16 v96, v36, v22, v96
    v_dot2_f32_bf16 v97, v36, v78, v97
    v_dot2_f32_bf16 v98, v37, v22, v98
    v_dot2_f32_bf16 v99, v37, v78, v99
    v_dot2_f32_bf16 v100, v38, v22, v100
    v_dot2_f32_bf16 v101, v38, v78, v101
    v_dot2_f32_bf16 v102, v39, v22, v102
    v_dot2_f32_bf16 v103, v39, v78, v103
    v_dot2_f32_bf16 v104, v36, v23, v104
    v_dot2_f32_bf16 v105, v36, v79, v105
    v_dot2_f32_bf16 v106, v37, v23, v106
    v_dot2_f32_bf16 v107, v37, v79, v107
    v_dot2_f32_bf16 v108, v38, v23, v108
    v_dot2_f32_bf16 v109, v38, v79, v109
    v_dot2_f32_bf16 v110, v39, v23, v110
    v_dot2_f32_bf16 v111, v39, v79, v111
    v_dot2_f32_bf16 v96, v40, v24, v96
    v_dot2_f32_bf16 v97, v40, v80, v97
    v_dot2_f32_bf16 v98, v41, v24, v98
    v_dot2_f32_bf16 v99, v41, v80, v99
    v_dot2_f32_bf16 v100, v42, v24, v100
    v_dot2_f32_bf16 v101, v42, v80, v101
    v_dot2_f32_bf16 v102, v43, v24, v102
    v_dot2_f32_bf16 v103, v43, v80, v103
    v_dot2_f32_bf16 v104, v40, v25, v104
    v_dot2_f32_bf16 v105, v40, v81, v105
    v_dot2_f32_bf16 v106, v41, v25, v106
    v_dot2_f32_bf16 v107, v41, v81, v107
    v_dot2_f32_bf16 v108, v42, v25, v108
    v_dot2_f32_bf16 v109, v42, v81, v109
    v_dot2_f32_bf16 v110, v43, v25, v110
    v_dot2_f32_bf16 v111, v43, v81, v111
    v_dot2_f32_bf16 v96, v44, v26, v96
    v_dot2_f32_bf16 v97, v44, v82, v97
    v_dot2_f32_bf16 v98, v45, v26, v98
    v_dot2_f32_bf16 v99, v45, v82, v99
    v_dot2_f32_bf16 v100, v46, v26, v100
    v_dot2_f32_bf16 v101, v46, v82, v101
    v_dot2_f32_bf16 v102, v47, v26, v102
    v_dot2_f32_bf16 v103, v47, v82, v103
    v_dot2_f32_bf16 v104, v44, v27, v104
    v_dot2_f32_bf16 v105, v44, v83, v105
    v_dot2_f32_bf16 v106, v45, v27, v106
    v_dot2_f32_bf16 v107, v45, v83, v107
    v_dot2_f32_bf16 v108, v46, v27, v108
    v_dot2_f32_bf16 v109, v46, v83, v109
    v_dot2_f32_bf16 v110, v47, v27, v110
    v_dot2_f32_bf16 v111, v47, v83, v111
    v_dot2_f32_bf16 v96, v48, v28, v96
    v_dot2_f32_bf16 v97, v48, v84, v97
    v_dot2_f32_bf16 v98, v49, v28, v98
    v_dot2_f32_bf16 v99, v49, v84, v99
    v_dot2_f32_bf16 v100, v50, v28, v100
    v_dot2_f32_bf16 v101, v50, v84, v101
    v_dot2_f32_bf16 v102, v51, v28, v102
    v_dot2_f32_bf16 v103, v51, v84, v103
    v_dot2_f32_bf16 v104, v48, v29, v104
    v_dot2_f32_bf16 v105, v48, v85, v105
    v_dot2_f32_bf16 v106, v49, v29, v106
    v_dot2_f32_bf16 v107, v49, v85, v107
    v_dot2_f32_bf16 v108, v50, v29, v108
    v_dot2_f32_bf16 v109, v50, v85, v109
    v_dot2_f32_bf16 v110, v51, v29, v110
    v_dot2_f32_bf16 v111, v51, v85, v111
    v_dot2_f32_bf16 v112, v52, v20, 0
    v_dot2_f32_bf16 v113, v52, v76, 0
    v_dot2_f32_bf16 v114, v53, v20, 0
    v_dot2_f32_bf16 v115, v53, v76, 0
    v_dot2_f32_bf16 v116, v52, v21, 0
    v_dot2_f32_bf16 v117, v52, v77, 0
    v_dot2_f32_bf16 v118, v53, v21, 0
    v_dot2_f32_bf16 v119, v53, v77, 0
    v_dot2_f32_bf16 v112, v54, v22, v112
    v_dot2_f32_bf16 v113, v54, v78, v113
    v_dot2_f32_bf16 v114, v55, v22, v114
    v_dot2_f32_bf16 v115, v55, v78, v115
    v_dot2_f32_bf16 v116, v54, v23, v116
    v_dot2_f32_bf16 v117, v54, v79, v117
    v_dot2_f32_bf16 v118, v55, v23, v118
    v_dot2_f32_bf16 v119, v55, v79, v119
    v_dot2_f32_bf16 v112, v56, v24, v112
    v_dot2_f32_bf16 v113, v56, v80, v113
    v_dot2_f32_bf16 v114, v57, v24, v114
    v_dot2_f32_bf16 v115, v57, v80, v115
    v_dot2_f32_bf16 v116, v56, v25, v116
    v_dot2_f32_bf16 v117, v56, v81, v117
    v_dot2_f32_bf16 v118, v57, v25, v118
    v_dot2_f32_bf16 v119, v57, v81, v119
    v_dot2_f32_bf16 v112, v58, v26, v112
    v_dot2_f32_bf16 v113, v58, v82, v113
    v_dot2_f32_bf16 v114, v59, v26, v114
    v_dot2_f32_bf16 v115, v59, v82, v115
    v_dot2_f32_bf16 v116, v58, v27, v116
    v_dot2_f32_bf16 v117, v58, v83, v117
    v_dot2_f32_bf16 v118, v59, v27, v118
    v_dot2_f32_bf16 v119, v59, v83, v119
    v_dot2_f32_bf16 v112, v60, v28, v112
    v_dot2_f32_bf16 v113, v60, v84, v113
    v_dot2_f32_bf16 v114, v61, v28, v114
    v_dot2_f32_bf16 v115, v61, v84, v115
    v_dot2_f32_bf16 v116, v60, v29, v116
    v_dot2_f32_bf16 v117, v60, v85, v117
    v_dot2_f32_bf16 v118, v61, v29, v118
    v_dot2_f32_bf16 v119, v61, v85, v119
    v_permlane32_swap_b32 v96, v104
    v_permlane32_swap_b32 v97, v105
    v_permlane32_swap_b32 v98, v106
    v_permlane32_swap_b32 v99, v107
    v_permlane32_swap_b32 v100, v108
    v_permlane32_swap_b32 v101, v109
    v_permlane32_swap_b32 v102, v110
    v_permlane32_swap_b32 v103, v111
    v_add_f32 v96, v96, v104
    v_add_f32 v97, v97, v105
    v_add_f32 v98, v98, v106
    v_add_f32 v99, v99, v107
    v_add_f32 v100, v100, v108
    v_add_f32 v101, v101, v109
    v_add_f32 v102, v102, v110
    v_add_f32 v103, v103, v111
    v_permlane16_swap_b32 v96, v100
    v_permlane16_swap_b32 v97, v101
    v_permlane16_swap_b32 v98, v102
    v_permlane16_swap_b32 v99, v103
    v_add_f32 v96, v96, v100
    v_add_f32 v97, v97, v101
    v_add_f32 v98, v98, v102
    v_add_f32 v99, v99, v103
    v_permlane32_swap_b32 v112, v116
    v_permlane32_swap_b32 v113, v117
    v_permlane32_swap_b32 v114, v118
    v_permlane32_swap_b32 v115, v119
    v_add_f32 v112, v112, v116
    v_add_f32 v113, v113, v117
    v_add_f32 v114, v114, v118
    v_add_f32 v115, v115, v119
    s_nop 0
    v_permlane16_swap_b32 v112, v114
    v_permlane16_swap_b32 v113, v115
    v_add_f32 v112, v112, v114
    v_add_f32 v113, v113, v115
    v_lshrrev_b32 v2, 1, v10
    v_and_b32 v3, 1, v10
    v_lshlrev_b32 v64, 9, v2
    v_lshl_add_u32 v64, v11, 5, v64
    v_lshl_add_u32 v64, v3, 4, v64
    s_lshl_b32 s10, s3, 10
    v_add_u32 v64, s10, v64
    ds_write_b128 v64, v[96:99] offset:0
    v_lshlrev_b32 v65, 8, v2
    v_lshl_add_u32 v65, v11, 4, v65
    v_lshl_add_u32 v65, v3, 3, v65
    s_lshl_b32 s10, s3, 9
    v_add_u32 v65, s10, v65
    ds_write_b64 v65, v[112:113] offset:4096
    s_movk_i32 s10, 320
    v_mul_u32_u24 v31, s10, v2
    v_lshl_add_u32 v31, v11, 5, v31
    v_lshl_add_u32 v31, v3, 4, v31
    s_mul_i32 s10, s3, 640
    v_add_u32 v31, s10, v31
    v_mov_b32 v12, 0
    v_mov_b32 v3, 1
    s_mov_b64 exec, 1
    ds_add_u32 v12, v3 offset:18048
    s_mov_b64 exec, -1
    s_mov_b32 s12, 2000000
L_spin7:
    ds_read_b32 v3, v12 offset:18048
    s_waitcnt lgkmcnt(0)
    v_readfirstlane_b32 s10, v3
    s_cmp_ge_u32 s10, 4
    s_cbranch_scc1 L_spin7_done
    s_sub_u32 s12, s12, 1
    s_cmp_lg_u32 s12, 0
    s_cbranch_scc1 L_spin7
L_spin7_done:
    s_cmp_eq_u32 s3, 3
    s_cbranch_scc1 L_h1_gather
    v_lshlrev_b32 v2, 3, v0
    s_cmp_eq_u32 s3, 2
    s_cbranch_scc1 L_h1_pubh
    s_lshl_b32 s10, s3, 9
    v_add_u32 v2, s10, v2
    ds_read_b64 v[68:69], v2 offset:0
    ds_read_b64 v[70:71], v2 offset:1024
    ds_read_b64 v[72:73], v2 offset:2048
    ds_read_b64 v[74:75], v2 offset:3072
    s_lshl_b32 s11, s3, 10
    s_branch L_h1_pub
L_h1_pubh:
    ds_read_b64 v[68:69], v2 offset:4096
    ds_read_b64 v[70:71], v2 offset:4608
    ds_read_b64 v[72:73], v2 offset:5120
    ds_read_b64 v[74:75], v2 offset:5632
    s_movk_i32 s11, 2048
L_h1_pub:
    s_mul_i32 s10, s6, 3072
    s_add_u32 s10, s10, s11
    v_lshl_add_u32 v3, v0, 4, s10
    v_mov_b32 v66, s68
    v_mov_b32 v67, s69
    s_waitcnt lgkmcnt(0)
    v_add_f32 v64, v68, v70
    v_add_f32 v65, v69, v71
    v_add_f32 v72, v72, v74
    v_add_f32 v73, v73, v75
    v_add_f32 v64, v64, v72
    v_add_f32 v65, v65, v73
    buffer_store_dwordx4 v[64:67], v3, s[56:59], 0 offen sc1
    s_mov_b64 exec, -1
    s_mul_i32 s10, s4, 4352
    s_lshl_b32 s11, s3, 6
    s_add_u32 s10, s10, s11
    s_lshl_b32 s11, s5, 3
    s_add_u32 s10, s10, s11
    s_add_u32 s10, s10, 3670016
    v_mov_b32 v3, s10
    s_mov_b64 exec, 1
    s_getreg_b32 s10, hwreg(HW_REG_XCC_ID)
    s_and_b32 s10, s10, 15
    s_xor_b32 s10, s10, s69
    v_mov_b32 v68, s68
    v_mov_b32 v69, s10
    buffer_store_dwordx2 v[68:69], v3, s[56:59], 0 offen sc1
    s_mov_b64 exec, -1
    s_cmp_eq_u32 s3, 2
    s_cbranch_scc1 L_h1_gather
    s_waitcnt vmcnt(2)
    s_mov_b32 s10, 0x05040100
    s_mov_b32 s11, 0x07060302
    v_perm_b32 v96, v124, v120, s10
    v_perm_b32 v124, v124, v120, s11
    v_perm_b32 v97, v125, v121, s10
    v_perm_b32 v125, v125, v121, s11
    v_perm_b32 v98, v126, v122, s10
    v_perm_b32 v126, v126, v122, s11
    v_perm_b32 v99, v127, v123, s10
    v_perm_b32 v127, v127, v123, s11
    v_perm_b32 v100, v132, v128, s10
    v_perm_b32 v132, v132, v128, s11
    v_perm_b32 v101, v133, v129, s10
    v_perm_b32 v133, v133, v129, s11
    v_perm_b32 v102, v134, v130, s10
    v_perm_b32 v134, v134, v130, s11
    v_perm_b32 v103, v135, v131, s10
    v_perm_b32 v135, v135, v131, s11
    s_mov_b32 s10, 0x05040100
    s_mov_b32 s11, 0x07060302
    v_perm_b32 v32, v140, v136, s10
    v_perm_b32 v33, v148, v144, s10
    v_perm_b32 v34, v156, v152, s10
    v_perm_b32 v35, v164, v160, s10
    v_perm_b32 v36, v140, v136, s11
    v_perm_b32 v37, v148, v144, s11
    v_perm_b32 v38, v156, v152, s11
    v_perm_b32 v39, v164, v160, s11
    v_perm_b32 v40, v141, v137, s10
    v_perm_b32 v41, v149, v145, s10
    v_perm_b32 v42, v157, v153, s10
    v_perm_b32 v43, v165, v161, s10
    v_perm_b32 v44, v141, v137, s11
    v_perm_b32 v45, v149, v145, s11
    v_perm_b32 v46, v157, v153, s11
    v_perm_b32 v47, v165, v161, s11
    v_perm_b32 v48, v142, v138, s10
    v_perm_b32 v49, v150, v146, s10
    v_perm_b32 v50, v158, v154, s10
    v_perm_b32 v51, v166, v162, s10
    v_perm_b32 v52, v142, v138, s11
    v_perm_b32 v53, v150, v146, s11
    v_perm_b32 v54, v158, v154, s11
    v_perm_b32 v55, v166, v162, s11
    v_perm_b32 v56, v143, v139, s10
    v_perm_b32 v57, v151, v147, s10
    v_perm_b32 v58, v159, v155, s10
    v_perm_b32 v59, v167, v163, s10
    v_perm_b32 v60, v143, v139, s11
    v_perm_b32 v61, v151, v147, s11
    v_perm_b32 v62, v159, v155, s11
    v_perm_b32 v63, v167, v163, s11
    s_cmp_lg_u32 s3, 0
    s_cbranch_scc1 L_nopre
    v_mov_b32 v64, 0
    v_mov_b32 v65, 0
    v_mov_b32 v66, 0
    v_mov_b32 v67, 0
    s_lshl_b32 s10, s6, 10
    s_add_u32 s10, s10, 4980736
    v_lshl_add_u32 v3, v0, 4, s10
    buffer_load_dwordx4 v[64:67], v3, s[56:59], 0 offen
    s_mul_i32 s10, s4, 4352
    s_lshl_b32 s11, s5, 7
    s_add_u32 s10, s10, s11
    s_add_u32 s10, s10, 7602176
    v_lshl_add_u32 v2, v0, 4, s10
    s_mov_b64 exec, 0xff
    buffer_load_dwordx4 v[68:71], v2, s[56:59], 0 offen
    s_mov_b64 exec, -1
    s_waitcnt vmcnt(0)
L_nopre:
    s_branch L_b3
L_h1_gather:
    s_lshl_b32 s10, s7, 10
    s_cmp_eq_u32 s3, 2
    s_cselect_b32 s10, 2048, s10
    s_mul_i32 s11, s4, 24576
    s_add_u32 s10, s10, s11
    v_lshl_add_u32 v3, v0, 4, s10
    s_mov_b32 s89, 3072
    s_mov_b32 s90, 6144
    s_mov_b32 s91, 9216
    s_mov_b32 s92, 12288
    s_mov_b32 s93, 15360
    s_mov_b32 s94, 18432
    s_mov_b32 s95, 21504
    s_cmp_eq_u32 s3, 2
    s_cbranch_scc1 L_pp2
    s_waitcnt vmcnt(0)
    s_branch L_pp
L_pp2:
    s_waitcnt vmcnt(2)
L_pp:
    s_mov_b32 s10, 0x05040100
    s_mov_b32 s11, 0x07060302
    v_perm_b32 v96, v124, v120, s10
    v_perm_b32 v124, v124, v120, s11
    v_perm_b32 v97, v125, v121, s10
    v_perm_b32 v125, v125, v121, s11
    v_perm_b32 v98, v126, v122, s10
    v_perm_b32 v126, v126, v122, s11
    v_perm_b32 v99, v127, v123, s10
    v_perm_b32 v127, v127, v123, s11
    v_perm_b32 v100, v132, v128, s10
    v_perm_b32 v132, v132, v128, s11
    v_perm_b32 v101, v133, v129, s10
    v_perm_b32 v133, v133, v129, s11
    v_perm_b32 v102, v134, v130, s10
    v_perm_b32 v134, v134, v130, s11
    v_perm_b32 v103, v135, v131, s10
    v_perm_b32 v135, v135, v131, s11
    s_mov_b32 s10, 0x05040100
    s_mov_b32 s11, 0x07060302
    v_perm_b32 v32, v140, v136, s10
    v_perm_b32 v33, v148, v144, s10
    v_perm_b32 v34, v156, v152, s10
    v_perm_b32 v35, v164, v160, s10
    v_perm_b32 v36, v140, v136, s11
    v_perm_b32 v37, v148, v144, s11
    v_perm_b32 v38, v156, v152, s11
    v_perm_b32 v39, v164, v160, s11
    v_perm_b32 v40, v141, v137, s10
    v_perm_b32 v41, v149, v145, s10
    v_perm_b32 v42, v157, v153, s10
    v_perm_b32 v43, v165, v161, s10
    v_perm_b32 v44, v141, v137, s11
    v_perm_b32 v45, v149, v145, s11
    v_perm_b32 v46, v157, v153, s11
    v_perm_b32 v47, v165, v161, s11
    v_perm_b32 v48, v142, v138, s10
    v_perm_b32 v49, v150, v146, s10
    v_perm_b32 v50, v158, v154, s10
    v_perm_b32 v51, v166, v162, s10
    v_perm_b32 v52, v142, v138, s11
    v_perm_b32 v53, v150, v146, s11
    v_perm_b32 v54, v158, v154, s11
    v_perm_b32 v55, v166, v162, s11
    v_perm_b32 v56, v143, v139, s10
    v_perm_b32 v57, v151, v147, s10
    v_perm_b32 v58, v159, v155, s10
    v_perm_b32 v59, v167, v163, s10
    v_perm_b32 v60, v143, v139, s11
    v_perm_b32 v61, v151, v147, s11
    v_perm_b32 v62, v159, v155, s11
    v_perm_b32 v63, v167, v163, s11
    s_cmp_eq_u32 s3, 2
    s_cselect_b32 s10, 2, s7
    s_lshl_b32 s10, s10, 6
    s_mul_i32 s11, s4, 4352
    s_add_u32 s10, s10, s11
    s_add_u32 s10, s10, 3670016
    s_add_u32 s14, s56, s10
    s_addc_u32 s15, s57, 0
    s_mov_b32 s12, 20000
L_hx:
    s_load_dwordx16 s[16:31], s[14:15], 0 glc
    s_waitcnt lgkmcnt(0)
    s_cmp_eq_u32 s16, s68
    s_cbranch_scc0 L_hx_no
    s_xor_b32 s17, s17, s69
    s_cmp_lt_u32 s17, 16
    s_cbranch_scc0 L_hx_no
    s_cmp_eq_u32 s18, s68
    s_cbranch_scc0 L_hx_no
    s_xor_b32 s19, s19, s69
    s_cmp_lt_u32 s19, 16
    s_cbranch_scc0 L_hx_no
    s_cmp_eq_u32 s20, s68
    s_cbranch_scc0 L_hx_no
    s_xor_b32 s21, s21, s69
    s_cmp_lt_u32 s21, 16
    s_cbranch_scc0 L_hx_no
    s_cmp_eq_u32 s22, s68
    s_cbranch_scc0 L_hx_no
    s_xor_b32 s23, s23, s69
    s_cmp_lt_u32 s23, 16
    s_cbranch_scc0 L_hx_no
    s_cmp_eq_u32 s24, s68
    s_cbranch_scc0 L_hx_no
    s_xor_b32 s25, s25, s69
    s_cmp_lt_u32 s25, 16
    s_cbranch_scc0 L_hx_no
    s_cmp_eq_u32 s26, s68
    s_cbranch_scc0 L_hx_no
    s_xor_b32 s27, s27, s69
    s_cmp_lt_u32 s27, 16
    s_cbranch_scc0 L_hx_no
    s_cmp_eq_u32 s28, s68
    s_cbranch_scc0 L_hx_no
    s_xor_b32 s29, s29, s69
    s_cmp_lt_u32 s29, 16
    s_cbranch_scc0 L_hx_no
    s_cmp_eq_u32 s30, s68
    s_cbranch_scc0 L_hx_no
    s_xor_b32 s31, s31, s69
    s_cmp_lt_u32 s31, 16
    s_cbranch_scc0 L_hx_no
    s_mov_b32 s11, 2
    s_cmp_eq_u32 s19, s17
    s_cselect_b32 s11, s11, 1
    s_cmp_eq_u32 s21, s17
    s_cselect_b32 s11, s11, 1
    s_cmp_eq_u32 s23, s17
    s_cselect_b32 s11, s11, 1
    s_cmp_eq_u32 s25, s17
    s_cselect_b32 s11, s11, 1
    s_cmp_eq_u32 s27, s17
    s_cselect_b32 s11, s11, 1
    s_cmp_eq_u32 s29, s17
    s_cselect_b32 s11, s11, 1
    s_cmp_eq_u32 s31, s17
    s_cselect_b32 s11, s11, 1
    s_branch L_hx_done
L_hx_no:
    s_sub_u32 s12, s12, 1
    s_cmp_lg_u32 s12, 0
    s_cbranch_scc1 L_hx
    s_mov_b32 s11, 1
L_hx_done:
    s_cmp_eq_u32 s3, 3
    s_cbranch_scc0 L_hx_nw
    v_mov_b32 v2, s11
    ds_write_b32 v12, v2 offset:18084
L_hx_nw:
    s_mov_b32 s12, 20000
L_poll1:
    buffer_load_dwordx4 v[64:67], v3, s[56:59], 0 offen sc1
    buffer_load_dwordx4 v[68:71], v3, s[56:59], s89 offen sc1
    buffer_load_dwordx4 v[72:75], v3, s[56:59], s90 offen sc1
    buffer_load_dwordx4 v[76:79], v3, s[56:59], s91 offen sc1
    buffer_load_dwordx4 v[80:83], v3, s[56:59], s92 offen sc1
    buffer_load_dwordx4 v[84:87], v3, s[56:59], s93 offen sc1
    buffer_load_dwordx4 v[88:91], v3, s[56:59], s94 offen sc1
    buffer_load_dwordx4 v[92:95], v3, s[56:59], s95 offen sc1
    s_waitcnt vmcnt(0)
    v_cmp_ne_u64 s[70:71], v[66:67], s[68:69]
    v_cmp_ne_u64 vcc, v[70:71], s[68:69]
    s_or_b64 s[70:71], s[70:71], vcc
    v_cmp_ne_u64 vcc, v[74:75], s[68:69]
    s_or_b64 s[70:71], s[70:71], vcc
    v_cmp_ne_u64 vcc, v[78:79], s[68:69]
    s_or_b64 s[70:71], s[70:71], vcc
    v_cmp_ne_u64 vcc, v[82:83], s[68:69]
    s_or_b64 s[70:71], s[70:71], vcc
    v_cmp_ne_u64 vcc, v[86:87], s[68:69]
    s_or_b64 s[70:71], s[70:71], vcc
    v_cmp_ne_u64 vcc, v[90:91], s[68:69]
    s_or_b64 s[70:71], s[70:71], vcc
    v_cmp_ne_u64 vcc, v[94:95], s[68:69]
    s_or_b64 s[70:71], s[70:71], vcc
    s_cmp_eq_u64 s[70:71], 0
    s_cbranch_scc1 L_poll1_done
    s_sub_u32 s12, s12, 1
    s_cmp_eq_u32 s12, 0
    s_cbranch_scc0 L_poll1
L_poll1_done:
    v_add_f32 v64, v64, v68
    v_add_f32 v72, v72, v76
    v_add_f32 v80, v80, v84
    v_add_f32 v88, v88, v92
    v_add_f32 v65, v65, v69
    v_add_f32 v73, v73, v77
    v_add_f32 v81, v81, v85
    v_add_f32 v89, v89, v93
    v_add_f32 v64, v64, v72
    v_add_f32 v80, v80, v88
    v_add_f32 v65, v65, v73
    v_add_f32 v81, v81, v89
    v_add_f32 v64, v64, v80
    v_add_f32 v65, v65, v81
    v_lshlrev_b32 v2, 2, v0
    s_cmp_eq_u32 s3, 2
    s_cbranch_scc0 L_qw
    v_max_f32 v64, 0, v64
    v_max_f32 v65, 0, v65
    v_add_u32 v2, 256, v2
L_qw:
    v_cvt_pk_bf16_f32 v64, v64, v65
    ds_write_b32 v2, v64 offset:6144
    v_mov_b32 v2, s68
    v_mov_b32 v3, s69
    ds_write_b64 v12, v[2:3] offset:10848
    s_cmp_eq_u32 s3, 2
    s_movk_i32 s10, 18052
    s_movk_i32 s11, 18056
    s_cselect_b32 s10, s11, s10
    v_mov_b32 v2, s10
    v_mov_b32 v3, 1
    ds_write_b32 v2, v3
L_b3:
    s_mov_b32 s12, 2000000
L_spin8:
    ds_read_b32 v3, v12 offset:18056
    s_waitcnt lgkmcnt(0)
    v_readfirstlane_b32 s10, v3
    s_cmp_ge_u32 s10, 1
    s_cbranch_scc1 L_spin8_done
    s_sub_u32 s12, s12, 1
    s_cmp_lg_u32 s12, 0
    s_cbranch_scc1 L_spin8
L_spin8_done:
    s_lshl_b32 s10, s3, 5
    v_lshl_add_u32 v2, v10, 3, s10
    ds_read_b64 v[64:65], v2 offset:6400
    ds_read_b64 v[66:67], v2 offset:6528
    s_waitcnt lgkmcnt(0)
    v_dot2_f32_bf16 v104, v96, v64, 0
    v_dot2_f32_bf16 v105, v124, v64, 0
    v_dot2_f32_bf16 v106, v97, v64, 0
    v_dot2_f32_bf16 v107, v125, v64, 0
    v_dot2_f32_bf16 v108, v98, v64, 0
    v_dot2_f32_bf16 v109, v126, v64, 0
    v_dot2_f32_bf16 v110, v99, v64, 0
    v_dot2_f32_bf16 v111, v127, v64, 0
    v_dot2_f32_bf16 v112, v96, v66, 0
    v_dot2_f32_bf16 v113, v124, v66, 0
    v_dot2_f32_bf16 v114, v97, v66, 0
    v_dot2_f32_bf16 v115, v125, v66, 0
    v_dot2_f32_bf16 v116, v98, v66, 0
    v_dot2_f32_bf16 v117, v126, v66, 0
    v_dot2_f32_bf16 v118, v99, v66, 0
    v_dot2_f32_bf16 v119, v127, v66, 0
    v_dot2_f32_bf16 v104, v100, v65, v104
    v_dot2_f32_bf16 v105, v132, v65, v105
    v_dot2_f32_bf16 v106, v101, v65, v106
    v_dot2_f32_bf16 v107, v133, v65, v107
    v_dot2_f32_bf16 v108, v102, v65, v108
    v_dot2_f32_bf16 v109, v134, v65, v109
    v_dot2_f32_bf16 v110, v103, v65, v110
    v_dot2_f32_bf16 v111, v135, v65, v111
    v_dot2_f32_bf16 v112, v100, v67, v112
    v_dot2_f32_bf16 v113, v132, v67, v113
    v_dot2_f32_bf16 v114, v101, v67, v114
    v_dot2_f32_bf16 v115, v133, v67, v115
    v_dot2_f32_bf16 v116, v102, v67, v116
    v_dot2_f32_bf16 v117, v134, v67, v117
    v_dot2_f32_bf16 v118, v103, v67, v118
    v_dot2_f32_bf16 v119, v135, v67, v119
    v_permlane32_swap_b32 v104, v112
    v_permlane32_swap_b32 v105, v113
    v_permlane32_swap_b32 v106, v114
    v_permlane32_swap_b32 v107, v115
    v_permlane32_swap_b32 v108, v116
    v_permlane32_swap_b32 v109, v117
    v_permlane32_swap_b32 v110, v118
    v_permlane32_swap_b32 v111, v119
    v_add_f32 v104, v104, v112
    v_add_f32 v105, v105, v113
    v_add_f32 v106, v106, v114
    v_add_f32 v107, v107, v115
    v_add_f32 v108, v108, v116
    v_add_f32 v109, v109, v117
    v_add_f32 v110, v110, v118
    v_add_f32 v111, v111, v119
    v_permlane16_swap_b32 v104, v108
    v_permlane16_swap_b32 v105, v109
    v_permlane16_swap_b32 v106, v110
    v_permlane16_swap_b32 v107, v111
    v_add_f32 v104, v104, v108
    v_add_f32 v105, v105, v109
    v_add_f32 v106, v106, v110
    v_add_f32 v107, v107, v111
    s_mov_b32 s10, 0x03ff03ff
    s_mov_b32 s11, 0x03ff03ff
    s_mov_b64 exec, s[10:11]
    ds_write_b128 v31, v[104:107] offset:11392
    s_mov_b64 exec, -1
    v_mov_b32 v3, 1
    s_mov_b64 exec, 1
    ds_add_rtn_u32 v3, v12, v3 offset:18072
    s_mov_b64 exec, -1
    s_waitcnt lgkmcnt(0)
    v_readfirstlane_b32 s10, v3
    s_cmp_eq_u32 s10, 3
    s_cbranch_scc0 L_noy2
    v_lshlrev_b32 v2, 3, v0
    ds_read_b64 v[72:73], v2 offset:11392
    ds_read_b64 v[74:75], v2 offset:12032
    ds_read_b64 v[76:77], v2 offset:12672
    ds_read_b64 v[78:79], v2 offset:13312
    ds_read_b64 v[80:81], v2 offset:11904
    ds_read_b64 v[82:83], v2 offset:12544
    ds_read_b64 v[84:85], v2 offset:13184
    ds_read_b64 v[86:87], v2 offset:13824
    s_mul_i32 s10, s4, 10240
    s_mul_i32 s11, s5, 1280
    s_add_u32 s10, s10, s11
    s_add_u32 s10, s10, 1638400
    v_lshl_add_u32 v3, v0, 4, s10
    v_add_u32 v2, 1024, v3
    v_mov_b32 v66, s68
    v_mov_b32 v67, s69
    v_mov_b32 v70, s68
    v_mov_b32 v71, s69
    s_waitcnt lgkmcnt(0)
    v_add_f32 v72, v72, v74
    v_add_f32 v76, v76, v78
    v_add_f32 v64, v72, v76
    v_add_f32 v73, v73, v75
    v_add_f32 v77, v77, v79
    v_add_f32 v65, v73, v77
    buffer_store_dwordx4 v[64:67], v3, s[56:59], 0 offen sc1
    v_add_f32 v80, v80, v82
    v_add_f32 v84, v84, v86
    v_add_f32 v68, v80, v84
    v_add_f32 v81, v81, v83
    v_add_f32 v85, v85, v87
    v_add_f32 v69, v81, v85
    s_mov_b64 exec, 0xffff
    buffer_store_dwordx4 v[68:71], v2, s[56:59], 0 offen sc1
    s_mov_b64 exec, -1
L_noy2:
    v_lshrrev_b32 v2, 1, v0
    v_and_b32 v2, 7, v2
    v_cmp_eq_u32 vcc, 0, v2
    s_nop 1
    v_cndmask_b32 v120, 0, -1, vcc
    v_cmp_eq_u32 vcc, 1, v2
    s_nop 1
    v_cndmask_b32 v121, 0, -1, vcc
    v_cmp_eq_u32 vcc, 2, v2
    s_nop 1
    v_cndmask_b32 v122, 0, -1, vcc
    v_cmp_eq_u32 vcc, 3, v2
    s_nop 1
    v_cndmask_b32 v123, 0, -1, vcc
    v_cmp_eq_u32 vcc, 4, v2
    s_nop 1
    v_cndmask_b32 v124, 0, -1, vcc
    v_cmp_eq_u32 vcc, 5, v2
    s_nop 1
    v_cndmask_b32 v125, 0, -1, vcc
    v_cmp_eq_u32 vcc, 6, v2
    s_nop 1
    v_cndmask_b32 v126, 0, -1, vcc
    v_cmp_eq_u32 vcc, 7, v2
    s_nop 1
    v_cndmask_b32 v127, 0, -1, vcc
    v_and_b32 v3, 1, v0
    v_lshlrev_b32 v3, 12, v3
    v_lshrrev_b32 v4, 1, v2
    v_lshl_add_u32 v3, v4, 10, v3
    v_lshl_add_u32 v3, v10, 6, v3
    v_and_b32 v4, 1, v2
    v_lshl_add_u32 v3, v4, 5, v3
    s_lshl_b32 s10, s4, 13
    s_lshl_b32 s11, s3, 8
    s_add_u32 s10, s10, s11
    s_add_u32 s10, s10, 786432
    v_add_u32 v13, s10, v3
    s_lshl_b32 s10, s3, 10
    v_lshl_add_u32 v14, v0, 4, s10
    v_lshlrev_b32 v3, 11, v11
    v_lshrrev_b32 v4, 1, v10
    v_lshl_add_u32 v3, v4, 10, v3
    v_and_b32 v4, 1, v10
    v_lshl_add_u32 v3, v4, 4, v3
    s_mul_i32 s10, s5, 20480
    s_lshl_b32 s11, s4, 5
    s_add_u32 s10, s10, s11
    s_add_u32 s10, s10, 1310720
    v_add_u32 v15, s10, v3
    v_lshlrev_b32 v16, 4, v0
    s_mul_i32 s10, s4, 10240
    s_mul_i32 s11, s5, 1280
    s_add_u32 s10, s10, s11
    s_add_u32 s10, s10, 1310720
    v_lshl_add_u32 v15, v0, 4, s10
    v_and_b32 v3, 3, v0
    v_lshrrev_b32 v4, 2, v0
    v_and_b32 v4, 15, v4
    v_lshl_add_u32 v3, v3, 4, v4
    v_lshlrev_b32 v16, 4, v3
    v_mov_b32 v22, s68
    v_mov_b32 v23, s69
    v_mov_b32 v26, s68
    v_mov_b32 v27, s69
    s_cmp_lg_u32 s3, 0
    s_cbranch_scc1 L_noml
    s_mov_b32 s12, 2000000
L_spin9:
    ds_read_b32 v3, v12 offset:18060
    s_waitcnt lgkmcnt(0)
    v_readfirstlane_b32 s10, v3
    s_cmp_ge_u32 s10, 8
    s_cbranch_scc1 L_spin9_done
    s_sleep 1
    s_sub_u32 s12, s12, 1
    s_cmp_lg_u32 s12, 0
    s_cbranch_scc1 L_spin9
L_spin9_done:
    ds_read_b128 v[64:67], v12 offset:10752
    ds_read_b128 v[68:71], v12 offset:10768
    ds_read_b128 v[72:75], v12 offset:10784
    ds_read_b128 v[76:79], v12 offset:10800
    v_mov_b32 v82, s68
    v_mov_b32 v83, s69
    s_mul_i32 s10, s4, 4352
    s_lshl_b32 s11, s5, 7
    s_add_u32 s10, s10, s11
    s_add_u32 s10, s10, 3407872
    v_mov_b32 v3, s10
    s_mov_b32 s14, 0x3fb8aa3b
    s_waitcnt lgkmcnt(0)
    v_max3_f32 v80, v64, v65, v66
    v_max3_f32 v80, v80, v67, v68
    v_max3_f32 v80, v80, v69, v70
    v_max_f32 v80, v80, v71
    v_sub_f32 v88, v64, v80
    v_sub_f32 v89, v65, v80
    v_sub_f32 v90, v66, v80
    v_sub_f32 v91, v67, v80
    v_sub_f32 v92, v68, v80
    v_sub_f32 v93, v69, v80
    v_sub_f32 v94, v70, v80
    v_sub_f32 v95, v71, v80
    v_mul_f32 v88, s14, v88
    v_mul_f32 v89, s14, v89
    v_mul_f32 v90, s14, v90
    v_mul_f32 v91, s14, v91
    v_mul_f32 v92, s14, v92
    v_mul_f32 v93, s14, v93
    v_mul_f32 v94, s14, v94
    v_mul_f32 v95, s14, v95
    v_exp_f32 v88, v88
    v_exp_f32 v89, v89
    v_exp_f32 v90, v90
    v_exp_f32 v91, v91
    v_exp_f32 v92, v92
    v_exp_f32 v93, v93
    v_exp_f32 v94, v94
    v_exp_f32 v95, v95
    s_mov_b64 exec, 1
    ds_write_b128 v12, v[88:91] offset:10816
    ds_write_b128 v12, v[92:95] offset:10832
    v_mov_b32 v4, 1
    ds_write_b32 v12, v4 offset:18064
    s_mov_b64 exec, -1
    v_mul_f32 v81, v88, v72
    v_fma_f32 v81, v89, v73, v81
    v_fma_f32 v81, v90, v74, v81
    v_fma_f32 v81, v91, v75, v81
    v_fma_f32 v81, v92, v76, v81
    v_fma_f32 v81, v93, v77, v81
    v_fma_f32 v81, v94, v78, v81
    v_fma_f32 v81, v95, v79, v81
    s_mov_b64 exec, 1
    ds_read_b32 v4, v12 offset:18084
    s_waitcnt lgkmcnt(0)
    v_readfirstlane_b32 s67, v4
    s_mov_b32 s10, 4194304
    s_cmp_eq_u32 s67, 2
    s_cbranch_scc0 L_ds_ml_g
    buffer_store_dwordx4 v[80:83], v3, s[56:59], s10 offen
    s_branch L_ds_ml_d
L_ds_ml_g:
    buffer_store_dwordx4 v[80:83], v3, s[56:59], 0 offen sc1
L_ds_ml_d:
    s_mov_b64 exec, -1
L_noml:
    v_and_b32 v3, 1, v0
    v_lshlrev_b32 v3, 9, v3
    v_lshrrev_b32 v4, 2, v0
    v_and_b32 v4, 3, v4
    v_lshl_add_u32 v3, v4, 7, v3
    s_mul_i32 s10, s4, 4352
    s_add_u32 s10, s10, 3407872
    v_add_u32 v18, s10, v3
    s_mul_i32 s9, s4, 4352
    s_add_u32 s9, s9, 3145728
    s_lshl_b32 s10, s5, 3
    s_add_u32 s10, s10, s9
    v_mov_b32 v19, s10
    s_mov_b32 s12, 2000000
L_spin10:
    ds_read_b32 v3, v12 offset:18064
    s_waitcnt lgkmcnt(0)
    v_readfirstlane_b32 s10, v3
    s_cmp_ge_u32 s10, 1
    s_cbranch_scc1 L_spin10_done
    s_sleep 4
    s_sub_u32 s12, s12, 1
    s_cmp_lg_u32 s12, 0
    s_cbranch_scc1 L_spin10
L_spin10_done:
    ds_read_b32 v3, v12 offset:18084
    s_waitcnt lgkmcnt(0)
    v_readfirstlane_b32 s67, v3
    s_mov_b32 s66, 4194304
    s_cmp_eq_u32 s67, 2
    s_cselect_b32 s66, s66, 0
    s_mov_b32 s13, s66
    s_mov_b32 s12, 20000
L_pollml:
    buffer_load_dwordx4 v[92:95], v18, s[56:59], s13 offen sc1
    s_waitcnt vmcnt(0)
    v_cmp_ne_u64 s[70:71], v[94:95], s[68:69]
    s_cmp_eq_u64 s[70:71], 0
    s_cbranch_scc1 L_pollml_done
    s_sleep 4
    s_cmp_lt_u32 s12, 19952
    s_cselect_b32 s10, 4194304, 0
    s_xor_b32 s13, s13, s10
    s_sub_u32 s12, s12, 1
    s_cmp_lg_u32 s12, 0
    s_cbranch_scc1 L_pollml
L_pollml_done:
    s_mov_b32 s14, 0x3fb8aa3b
    v_max_f32_dpp v5, v92, v92 row_ror:4 row_mask:0xf bank_mask:0xf
    s_nop 1
    v_max_f32_dpp v5, v5, v5 row_ror:8 row_mask:0xf bank_mask:0xf
    v_sub_f32 v6, v92, v5
    v_mul_f32 v6, s14, v6
    v_exp_f32 v6, v6
    s_nop 0
    v_mul_f32 v7, v6, v93
    s_nop 1
    v_add_f32_dpp v7, v7, v7 row_ror:4 row_mask:0xf bank_mask:0xf
    s_nop 1
    v_add_f32_dpp v7, v7, v7 row_ror:8 row_mask:0xf bank_mask:0xf
    v_rcp_f32 v7, v7
    s_nop 0
    v_mul_f32 v17, v6, v7
    s_mov_b32 s12, 2000000
L_spin11:
    ds_read_b32 v3, v12 offset:18080
    s_waitcnt lgkmcnt(0)
    v_readfirstlane_b32 s10, v3
    s_cmp_ge_u32 s10, 8
    s_cbranch_scc1 L_spin11_done
    s_sleep 1
    s_sub_u32 s12, s12, 1
    s_cmp_lg_u32 s12, 0
    s_cbranch_scc1 L_spin11
L_spin11_done:
    s_mov_b32 s13, s66
    s_mov_b32 s9, 640
    s_mov_b32 s14, 0x3fb8aa3b
    s_mov_b32 s12, 20000
    s_mov_b64 s[38:39], -1
    buffer_load_dwordx4 v[64:67], v13, s[56:59], s13 offen sc1
    buffer_load_dwordx4 v[68:71], v13, s[56:59], s13 offen offset:16 sc1
    s_cmp_lt_u32 s12, 19952
    s_cselect_b32 s10, 4194304, 0
    s_xor_b32 s13, s13, s10
L_pollH2:
    s_waitcnt vmcnt(0)
    v_cmp_eq_u64 s[70:71], v[66:67], s[68:69]
    v_cmp_eq_u64 vcc, v[70:71], s[68:69]
    s_and_b64 s[70:71], s[70:71], vcc
    s_and_b64 exec, s[70:71], s[38:39]
    v_mov_b32 v4, v64
    v_mov_b32 v5, v65
    v_mov_b32 v6, v68
    v_mov_b32 v7, v69
    s_andn2_b64 s[38:39], s[38:39], s[70:71]
    s_mov_b64 exec, s[38:39]
    s_cbranch_scc0 L_pollH2_done
    buffer_load_dwordx4 v[64:67], v13, s[56:59], s13 offen sc1
    buffer_load_dwordx4 v[68:71], v13, s[56:59], s13 offen offset:16 sc1
    s_cmp_lt_u32 s12, 19952
    s_cselect_b32 s10, 4194304, 0
    s_xor_b32 s13, s13, s10
    s_mov_b64 exec, -1
    s_sub_u32 s12, s12, 1
    s_cmp_lg_u32 s12, 0
    s_cbranch_scc1 L_pollH2
L_pollH2_done:
    s_mov_b64 exec, -1
    v_mul_f32 v4, v17, v4
    v_mul_f32 v5, v17, v5
    v_mul_f32 v6, v17, v6
    v_mul_f32 v7, v17, v7
    v_add_f32_dpp v4, v4, v4 row_ror:4 row_mask:0xf bank_mask:0xf
    v_add_f32_dpp v5, v5, v5 row_ror:4 row_mask:0xf bank_mask:0xf
    v_add_f32_dpp v6, v6, v6 row_ror:4 row_mask:0xf bank_mask:0xf
    v_add_f32_dpp v7, v7, v7 row_ror:4 row_mask:0xf bank_mask:0xf
    v_add_f32_dpp v4, v4, v4 row_ror:8 row_mask:0xf bank_mask:0xf
    v_add_f32_dpp v5, v5, v5 row_ror:8 row_mask:0xf bank_mask:0xf
    v_add_f32_dpp v6, v6, v6 row_ror:8 row_mask:0xf bank_mask:0xf
    v_add_f32_dpp v7, v7, v7 row_ror:8 row_mask:0xf bank_mask:0xf
    v_cvt_pk_bf16_f32 v2, v4, v5
    v_cvt_pk_bf16_f32 v3, v6, v7
    v_and_b32 v136, v2, v120
    v_and_b32 v137, v3, v120
    v_and_b32 v138, v2, v121
    v_and_b32 v139, v3, v121
    v_and_b32 v140, v2, v122
    v_and_b32 v141, v3, v122
    v_and_b32 v142, v2, v123
    v_and_b32 v143, v3, v123
    v_and_b32 v144, v2, v124
    v_and_b32 v145, v3, v124
    v_and_b32 v146, v2, v125
    v_and_b32 v147, v3, v125
    v_and_b32 v148, v2, v126
    v_and_b32 v149, v3, v126
    v_and_b32 v150, v2, v127
    v_and_b32 v151, v3, v127
    v_mfma_f32_16x16x32_bf16 v[96:99], v[136:139], v[32:35], 0
    v_mfma_f32_16x16x32_bf16 v[100:103], v[136:139], v[36:39], 0
    v_mfma_f32_16x16x32_bf16 v[96:99], v[140:143], v[40:43], v[96:99]
    v_mfma_f32_16x16x32_bf16 v[100:103], v[140:143], v[44:47], v[100:103]
    v_mfma_f32_16x16x32_bf16 v[96:99], v[144:147], v[48:51], v[96:99]
    v_mfma_f32_16x16x32_bf16 v[100:103], v[144:147], v[52:55], v[100:103]
    v_mfma_f32_16x16x32_bf16 v[96:99], v[148:151], v[56:59], v[96:99]
    v_mfma_f32_16x16x32_bf16 v[100:103], v[148:151], v[60:63], v[100:103]
    s_nop 6
    v_add_f32 v104, v96, v98
    v_add_f32 v105, v100, v102
    v_add_f32 v106, v97, v99
    v_add_f32 v107, v101, v103
    ds_write_b128 v14, v[104:107] offset:13952
    v_mov_b32 v3, 1
    s_mov_b64 exec, 1
    ds_add_rtn_u32 v3, v12, v3 offset:18076
    s_mov_b64 exec, -1
    s_waitcnt lgkmcnt(0)
    v_readfirstlane_b32 s10, v3
    s_cmp_eq_u32 s10, 3
    s_cbranch_scc0 L_fin
    ds_read_b128 v[104:107], v16 offset:13952
    ds_read_b128 v[108:111], v16 offset:14976
    ds_read_b128 v[112:115], v16 offset:16000
    ds_read_b128 v[116:119], v16 offset:17024
    s_mov_b32 s10, -1
    s_mov_b32 s11, 0xff
    s_waitcnt lgkmcnt(2)
    v_add_f32 v104, v104, v108
    v_add_f32 v105, v105, v109
    v_add_f32 v106, v106, v110
    v_add_f32 v107, v107, v111
    s_waitcnt lgkmcnt(0)
    v_add_f32 v112, v112, v116
    v_add_f32 v113, v113, v117
    v_add_f32 v114, v114, v118
    v_add_f32 v115, v115, v119
    v_add_f32 v20, v104, v112
    v_add_f32 v21, v105, v113
    v_add_f32 v24, v106, v114
    v_add_f32 v25, v107, v115
    s_mov_b64 exec, s[10:11]
    buffer_store_dwordx4 v[20:23], v15, s[56:59], 0 offen sc1
    buffer_store_dwordx4 v[24:27], v15, s[56:59], s9 offen sc1
    s_mov_b64 exec, -1
L_fin:
L_end:
    s_endpgm
.section .rodata,"a"
.p2align 6
.amdhsa_kernel recurrent_scan__sliding_block_cached__dense_activation_relu__decode_kernel
  .amdhsa_next_free_vgpr 168
  .amdhsa_next_free_sgpr 96
  .amdhsa_accum_offset 168
  .amdhsa_group_segment_fixed_size 0
  .amdhsa_kernarg_size 88
  .amdhsa_user_sgpr_count 2
  .amdhsa_user_sgpr_kernarg_segment_ptr 1
  .amdhsa_system_sgpr_workgroup_id_x 1
.end_amdhsa_kernel
```
